```python
import torch

def _softmax(x, axis=-1):
    return torch.softmax(x, dim=axis)
def _gelu(x):
    return torch.nn.functional.gelu(x, approximate="tanh")
def _silu(x):
    return torch.nn.functional.silu(x)
def _sigmoid(x):
    return torch.sigmoid(x)
def _layernorm(x, axis=-1, eps=1e-5):
    m = x.mean(dim=axis, keepdim=True)
    v = x.var(dim=axis, keepdim=True, unbiased=False)
    return (x - m) / torch.sqrt(v + eps)
def _scatter_add(tgt, idx, src, axis=0):
    return tgt.clone().index_add_(axis, idx, src)
def _segment_sum(src, seg, n):
    out = torch.zeros((n,) + src.shape[1:], dtype=src.dtype)
    return out.index_add_(0, seg, src)
def _pad(x, pw):
    flat = tuple(v for pair in reversed(pw) for v in pair)
    return torch.nn.functional.pad(x, flat)

kernel_name = 'standalone__cheap_equivariant_egnn__graph'

def setup_inputs():

    _w = (lambda a: (lambda t: t.to(torch.bfloat16) if t.is_floating_point() else t)(torch.as_tensor(a)))
    N, deg, D, De = 10000, 64, 64, max(4, 1)
    E = N * deg
    return {
        "h": _w((lambda *s: torch.randn(*s, dtype=torch.bfloat16) * 0.2)(N, D)),
        "pos": _w((lambda *s: torch.randn(*s, dtype=torch.bfloat16) * 0.8)(N, 3)),
        "e_attr": _w((lambda *s: torch.randn(*s, dtype=torch.bfloat16) * 0.8)(E, De)),
        "src": _w((lambda lo, hi, *s: torch.randint(lo, hi, s))(0, N, E).to(torch.int64)),
        "dst": _w((lambda lo, hi, *s: torch.randint(lo, hi, s))(0, N, E).to(torch.int64)),
        "w_e": _w(0.1 * (lambda *s: torch.randn(*s, dtype=torch.bfloat16) * 0.8)(2 * D + 1 + De, D)),
        "w_x": _w(0.1 * (lambda *s: torch.randn(*s, dtype=torch.bfloat16) * 0.2)(D, 1)),
        "w_h": _w(0.1 * (lambda *s: torch.randn(*s, dtype=torch.bfloat16) * 0.2)(2 * D, D)),
    }

def reference(h, pos, e_attr, src, dst, w_e, w_x, w_h):
    N, D = h.shape[0], h.shape[1]
    diff = pos[dst] - pos[src]
    dist2 = torch.sum(diff * diff, axis=-1, keepdims=True)
    e_in = torch.concatenate([h[dst], h[src], dist2, e_attr], axis=-1)
    m_ij = _silu(e_in @ w_e)
    coord_scale = m_ij @ w_x
    pos_new = pos + _segment_sum(diff * coord_scale, dst, N)
    m_i = _segment_sum(m_ij, dst, N)
    h_new = h + _silu(torch.concatenate([h, m_i], axis=-1) @ w_h)
    return h_new, pos_new
```

```asm
; @launch grid=(256,1,1) block=(512,1,1) lds=163840
.amdgcn_target "amdgcn-amd-amdhsa--gfx950"
.text
.globl standalone__cheap_equivariant_egnn__graph_kernel
.p2align 8
.type standalone__cheap_equivariant_egnn__graph_kernel,@function
standalone__cheap_equivariant_egnn__graph_kernel:
    s_load_dwordx2 s[32:33], s[0:1], 32
    s_load_dwordx2 s[48:49], s[0:1], 72
    s_getpc_b64 s[64:65]
L_pc:
    v_lshlrev_b32 v8, 5, v0
    v_min_u32 v8, L_done-L_pc, v8
    global_load_dword v243, v8, s[64:65]
    s_cmp_ge_u32 s2, 256
    s_cbranch_scc1 L_done
    s_and_b32 s3, s2, 7
    s_lshr_b32 s79, s2, 3
    s_lshl_b32 s3, s3, 5
    s_add_u32 s28, s79, s3
    s_mul_i32 s52, s28, 10000
    s_add_u32 s53, s52, 8192
    v_lshlrev_b32 v2, 4, v0
    v_lshlrev_b32 v7, 2, v0
    s_mov_b32 s34, 2560000
    s_mov_b32 s35, 0x20000
    s_waitcnt lgkmcnt(0)
    buffer_load_dwordx4 v[88:91], v2, s[32:35], s52 offen nt
    buffer_load_dword v92, v7, s[32:35], s53 offen nt
    s_load_dwordx2 s[36:37], s[0:1], 24
    s_load_dwordx2 s[40:41], s[0:1], 40
    s_load_dwordx2 s[4:5], s[0:1], 0
    s_load_dwordx2 s[16:17], s[0:1], 80
    s_load_dwordx2 s[8:9], s[0:1], 8
    s_load_dwordx2 s[12:13], s[0:1], 16
    s_load_dwordx2 s[44:45], s[0:1], 56
    s_load_dwordx2 s[24:25], s[0:1], 48
    s_load_dwordx2 s[76:77], s[0:1], 64
    s_memrealtime s[60:61]
    s_mul_i32 s96, s28, 625
    s_add_u32 s97, s96, 640
    s_add_u32 s96, s96, 15
    s_lshr_b32 s96, s96, 4
    s_lshr_b32 s97, s97, 4
    s_sub_u32 s97, s97, s96
    v_lshrrev_b32 v3, 6, v0
    v_and_b32 v1, 63, v0
    v_readfirstlane_b32 s29, v3
    s_mov_b32 s38, 2560000
    s_mov_b32 s39, 0x20000
    s_mov_b32 s42, 17024
    s_mov_b32 s43, 0x20000
    s_mov_b32 s6, 10000
    s_mov_b32 s7, 0x20000
    s_mov_b32 s50, 256
    s_mov_b32 s51, 0x20000
    s_mov_b32 s18, 5015808
    s_mov_b32 s19, 0x20000
    s_mov_b32 s10, 60000
    s_mov_b32 s11, 0x20000
    s_mov_b32 s14, 5120000
    s_mov_b32 s15, 0x20000
    s_mov_b32 s46, 16384
    s_mov_b32 s47, 0x20000
    s_mov_b32 s26, 128
    s_mov_b32 s27, 0x20000
    v_lshlrev_b32 v3, 4, v1
    v_and_b32 v4, 31, v0
    v_bfe_u32 v5, v0, 5, 1
    v_lshrrev_b32 v9, 3, v1
    v_lshrrev_b32 v10, 4, v1
    v_and_b32 v11, 7, v0
    v_xor_b32 v10, v11, v10
    v_lshlrev_b32 v185, 4, v10
    v_mov_b32 v200, 0
    v_mov_b32 v201, 0
    v_mov_b32 v202, 0
    v_mov_b32 v203, 0
    ds_write_b128 v2, v[200:203] offset:24576
    s_waitcnt lgkmcnt(0)
    s_or_b32 s54, s2, s29
    s_cmp_lg_u32 s54, 0
    s_cbranch_scc1 L_nononce
    s_or_b32 s60, s60, 1
    v_mov_b32 v8, s60
    s_mov_b64 exec, 1
    buffer_store_dword v8, v200, s[48:51], 0 offen sc1
    s_mov_b64 exec, -1
L_nononce:
    s_barrier
    buffer_load_dwordx4 v[96:99], v2, s[36:39], s52 offen nt
    buffer_load_dword v100, v7, s[36:39], s53 offen nt
    s_or_b32 s5, s5, 8388608
    s_lshl_b32 s83, s29, 10
    s_lshl3_add_u32 s55, s29, s96
    s_cmp_ge_u32 s29, 5
    s_cselect_b32 s55, 10000, s55
    v_add_u32 v150, s55, v9
    s_and_b32 s89, s29, 1
    s_lshl_b32 s57, s89, 6
    v_xor_b32 v151, s57, v185
    s_add_u32 m0, s83, 53248
    s_nop 0
    buffer_load_dwordx4 v[150:151], s[4:7], 0 idxen offen nt lds
    s_add_u32 s79, s79, s29
    s_add_u32 s84, s79, 0
    s_and_b32 s84, s84, 15
    s_min_u32 s84, s84, 14
    s_lshl_b32 s84, s84, 12
    s_add_u32 s85, s79, 8
    s_and_b32 s85, s85, 15
    s_min_u32 s85, s85, 14
    s_lshl_b32 s85, s85, 12
    s_mul_i32 s55, s96, 6
    s_mul_i32 s56, s29, 30
    s_add_u32 s95, s55, s56
    s_and_b32 s56, s29, 3
    s_lshl_b32 s56, s56, 12
    v_lshlrev_b32 v8, 1, v1
    v_mov_b32 v15, 0
    v_mov_b32 v214, 0
    v_mov_b32 v215, 0
    v_lshlrev_b32 v165, 1, v4
    s_bfe_u32 s88, s29, 0x10001
    s_lshl_b32 s75, s29, 12
    s_add_u32 s75, s75, 69632
    s_mov_b32 s86, 0xbfb8aa3b
    s_mov_b32 s87, 0xbfb8aa3b
    v_bfe_u32 v9, v0, 1, 3
    v_xor_b32 v9, v9, v5
    v_lshlrev_b32 v9, 4, v9
    v_lshl_add_u32 v9, v4, 7, v9
    v_add_u32 v192, s75, v9
    v_xor_b32 v193, 32, v192
    v_xor_b32 v194, 64, v192
    v_xor_b32 v195, 96, v192
    s_lshl_b32 s58, s88, 12
    s_add_u32 s59, s58, 53248
    v_add_u32 v160, s59, v9
    v_xor_b32 v161, 32, v160
    v_xor_b32 v162, 64, v160
    v_xor_b32 v163, 96, v160
    v_lshlrev_b32 v167, 4, v11
    v_xor_b32 v167, s57, v167
    v_lshl_add_u32 v167, v4, 7, v167
    v_lshl_add_u32 v167, v5, 3, v167
    v_add_u32 v167, s58, v167
    v_bfe_u32 v166, v0, 3, 3
    v_lshlrev_b32 v166, 4, v166
    v_xor_b32 v166, v166, v2
    s_lshl_b32 s78, s29, 11
    s_add_u32 s78, s78, 53248
    v_bfe_u32 v9, v0, 4, 1
    v_and_b32 v10, 3, v0
    v_lshlrev_b32 v10, 3, v10
    v_lshl_add_u32 v10, v9, 5, v10
    v_bfe_u32 v9, v0, 2, 2
    v_lshl_add_u32 v206, v9, 6, v10
    v_lshl_add_u32 v206, v5, 8, v206
    v_add_u32 v206, s78, v206
    v_lshl_add_u32 v164, v9, 7, v10
    v_lshl_add_u32 v164, v5, 10, v164
    s_add_u32 s57, s57, 69632
    v_add_u32 v164, s57, v164
    v_mov_b32 v213, 0x3f80
    v_lshlrev_b32 v148, 22, v0
    v_lshlrev_b32 v149, 20, v0
    v_add_u32 v149, 0x80000000, v149
    s_mov_b32 s61, 625
    v_cmp_gt_u32 vcc, 452, v0
    s_mov_b64 s[70:71], vcc
    s_mov_b32 s94, 0
    v_lshrrev_b32 v240, 1, v0
    v_mul_u32_u24 v12, 10240, v240
    v_mul_u32_u24 v241, 20000, v240
    v_add_u32 v242, 69632, v7
    v_and_b32 v6, 1, v0
    v_lshlrev_b32 v218, 4, v4
    v_xor_b32 v187, 64, v185
    v_mov_b32 v189, v185
    v_xor_b32 v191, 64, v185
    v_sub_u32 v209, 2, v5
    v_lshl_add_u32 v9, v4, 6, s78
    v_mul_u32_u24 v211, v9, v5
    v_lshlrev_b32 v212, 6, v5
    s_mul_i32 s55, s29, 2688
    s_add_u32 s55, s55, 102400
    v_mul_u32_u24 v216, 144, v5
    v_add3_u32 v216, v216, v165, s55
    v_lshl_add_u32 v217, v1, 2, s55
    v_mov_b32 v244, 0
    s_mov_b32 s90, -1
    s_mov_b32 s91, 0
    s_mov_b32 s92, 0
    s_mov_b32 s93, -1
    s_add_u32 s20, s16, 3670016
    s_addc_u32 s21, s17, 0
    s_or_b32 s21, s21, 8388608
    s_mov_b32 s22, 10000
    s_mov_b32 s23, 0x20000
    s_mov_b32 s30, 0
    s_mov_b32 s31, 256
    v_lshlrev_b32 v13, 12, v240
    v_lshlrev_b32 v14, 5, v0
    v_mov_b32 v11, 1
    s_add_u32 s54, s83, 8192
    s_add_u32 m0, s54, 69632
    buffer_load_dwordx4 v3, s[40:43], s54 offen lds
    s_add_u32 m0, s83, 69632
    s_nop 0
    buffer_load_dwordx4 v3, s[40:43], s83 offen lds
    s_mul_i32 s52, s28, 10240
    s_add_u32 s53, s52, 8192
    s_waitcnt vmcnt(5)
    v_mul_u32_u24 v9, 214749, v88
    v_lshrrev_b32 v9, 23, v9
    v_mad_u32_u24 v10, v9, s61, 15
    v_lshrrev_b32 v10, 4, v10
    v_sub_u32 v88, v88, v10
    v_lshrrev_b32 v10, 3, v88
    v_lshl_add_u32 v10, v9, 3, v10
    v_lshlrev_b32 v104, 2, v10
    ds_add_rtn_u32 v112, v104, v11 offset:24576
    v_mul_u32_u24 v9, 214749, v89
    v_lshrrev_b32 v9, 23, v9
    v_mad_u32_u24 v10, v9, s61, 15
    v_lshrrev_b32 v10, 4, v10
    v_sub_u32 v89, v89, v10
    v_lshrrev_b32 v10, 3, v89
    v_lshl_add_u32 v10, v9, 3, v10
    v_lshlrev_b32 v105, 2, v10
    ds_add_rtn_u32 v113, v105, v11 offset:24576
    v_mul_u32_u24 v9, 214749, v90
    v_lshrrev_b32 v9, 23, v9
    v_mad_u32_u24 v10, v9, s61, 15
    v_lshrrev_b32 v10, 4, v10
    v_sub_u32 v90, v90, v10
    v_lshrrev_b32 v10, 3, v90
    v_lshl_add_u32 v10, v9, 3, v10
    v_lshlrev_b32 v106, 2, v10
    ds_add_rtn_u32 v114, v106, v11 offset:24576
    v_mul_u32_u24 v9, 214749, v91
    v_lshrrev_b32 v9, 23, v9
    v_mad_u32_u24 v10, v9, s61, 15
    v_lshrrev_b32 v10, 4, v10
    v_sub_u32 v91, v91, v10
    v_lshrrev_b32 v10, 3, v91
    v_lshl_add_u32 v10, v9, 3, v10
    v_lshlrev_b32 v107, 2, v10
    ds_add_rtn_u32 v115, v107, v11 offset:24576
    v_mul_u32_u24 v9, 214749, v92
    v_lshrrev_b32 v9, 23, v9
    v_mad_u32_u24 v10, v9, s61, 15
    v_lshrrev_b32 v10, 4, v10
    v_sub_u32 v92, v92, v10
    v_lshrrev_b32 v10, 3, v92
    v_lshl_add_u32 v10, v9, 3, v10
    v_lshlrev_b32 v108, 2, v10
    s_mov_b64 exec, s[70:71]
    ds_add_rtn_u32 v116, v108, v11 offset:24576
    s_mov_b64 exec, -1
    s_waitcnt lgkmcnt(0)
    s_barrier
    s_cmp_ge_u32 s29, 4
    s_cbranch_scc1 L_p1_b
    ds_read_b128 v[72:75], v14 offset:24576
    ds_read_b32 v76, v14 offset:24592
    buffer_load_dword v245, v200, s[48:51], 0 offen sc1
    v_lshl_or_b32 v88, v88, 14, v148
    v_lshl_or_b32 v89, v89, 14, v148
    v_or_b32 v89, 1048576, v89
    v_lshl_or_b32 v90, v90, 14, v148
    v_or_b32 v90, 2097152, v90
    v_lshl_or_b32 v91, v91, 14, v148
    v_or_b32 v91, 3145728, v91
    v_lshl_or_b32 v92, v92, 14, v149
    s_lshl_b32 s54, s29, 2
    v_mov_b32 v9, s54
    s_waitcnt lgkmcnt(0)
    v_add_u32 v73, v72, v73
    v_add_u32 v74, v73, v74
    v_add_u32 v75, v74, v75
    v_add_u32 v76, v75, v76
    v_mov_b32 v77, v76
    s_nop 1
    v_add_u32_dpp v77, v77, v77 row_shr:1 row_mask:0xf bank_mask:0xf bound_ctrl:0
    s_nop 1
    v_add_u32_dpp v77, v77, v77 row_shr:2 row_mask:0xf bank_mask:0xf bound_ctrl:0
    s_nop 1
    v_add_u32_dpp v77, v77, v77 row_shr:4 row_mask:0xf bank_mask:0xf bound_ctrl:0
    s_nop 1
    v_add_u32_dpp v77, v77, v77 row_shr:8 row_mask:0xf bank_mask:0xf bound_ctrl:0
    s_nop 1
    v_add_u32_dpp v77, v77, v77 row_bcast:15 row_mask:0xa bank_mask:0xf
    s_nop 1
    v_add_u32_dpp v77, v77, v77 row_bcast:31 row_mask:0xc bank_mask:0xf
    s_nop 1
    s_mov_b32 exec_lo, 0
    s_mov_b32 exec_hi, 0x80000000
    ds_write_b32 v9, v77 offset:1664
    s_mov_b64 exec, -1
    v_sub_u32 v77, v77, v76
    s_waitcnt lgkmcnt(0)
    s_barrier
    ds_read_b128 v[80:83], v200 offset:1664
    s_waitcnt lgkmcnt(0)
    v_readfirstlane_b32 s64, v80
    v_readfirstlane_b32 s65, v81
    v_readfirstlane_b32 s66, v82
    s_cmp_gt_u32 s29, 0
    s_cselect_b32 s64, s64, 0
    s_cmp_gt_u32 s29, 1
    s_cselect_b32 s65, s65, 0
    s_cmp_gt_u32 s29, 2
    s_cselect_b32 s66, s66, 0
    s_add_u32 s64, s64, s65
    s_add_u32 s64, s64, s66
    v_add_u32 v80, s64, v77
    v_add_u32 v81, v80, v72
    v_add_u32 v82, v80, v73
    v_add_u32 v83, v80, v74
    v_add_u32 v84, v80, v75
    v_add_u32 v85, v80, v76
    ds_write_b128 v14, v[80:83] offset:24576
    ds_write_b32 v14, v84 offset:24592
    v_lshl_or_b32 v144, v81, 16, v80
    v_lshl_or_b32 v145, v83, 16, v82
    v_lshl_or_b32 v146, v85, 16, v84
    s_waitcnt lgkmcnt(0)
    s_barrier
    ds_read_b32 v104, v104 offset:24576
    ds_read_b32 v105, v105 offset:24576
    ds_read_b32 v106, v106 offset:24576
    ds_read_b32 v107, v107 offset:24576
    ds_read_b32 v108, v108 offset:24576
    s_waitcnt vmcnt(0)
    s_branch L_p1_j
L_p1_b:
    buffer_load_dword v245, v200, s[48:51], 0 offen sc1
    s_add_u32 m0, s56, 86016
    s_nop 0
    buffer_load_dwordx4 v3, s[44:47], s56 offen offset:0 lds
    buffer_load_dwordx4 v3, s[44:47], s56 offen offset:1024 lds
    buffer_load_dwordx4 v3, s[44:47], s56 offen offset:2048 lds
    buffer_load_dwordx4 v3, s[44:47], s56 offen offset:3072 lds
    v_lshl_or_b32 v88, v88, 14, v148
    v_lshl_or_b32 v89, v89, 14, v148
    v_or_b32 v89, 1048576, v89
    v_lshl_or_b32 v90, v90, 14, v148
    v_or_b32 v90, 2097152, v90
    v_lshl_or_b32 v91, v91, 14, v148
    v_or_b32 v91, 3145728, v91
    v_lshl_or_b32 v92, v92, 14, v149
    s_barrier
    s_add_u32 m0, s84, 102400
    s_nop 0
    buffer_load_dwordx4 v3, s[8:11], s84 offen offset:0 lds
    buffer_load_dwordx4 v3, s[8:11], s84 offen offset:1024 lds
    s_add_u32 m0, s84, 102400
    s_nop 0
    buffer_load_dwordx4 v3, s[8:11], s84 offen offset:2048 lds
    buffer_load_dwordx4 v3, s[8:11], s84 offen offset:3072 lds
    s_barrier
    ds_read_b32 v104, v104 offset:24576
    ds_read_b32 v105, v105 offset:24576
    ds_read_b32 v106, v106 offset:24576
    ds_read_b32 v107, v107 offset:24576
    ds_read_b32 v108, v108 offset:24576
    s_waitcnt vmcnt(8)
L_p1_j:
L_nonce0:
    v_readfirstlane_b32 s63, v245
    s_cmp_lg_u32 s63, 0
    s_cbranch_scc1 L_nonce_ok0
    s_add_u32 s94, s94, 1
    s_cmp_gt_u32 s94, 40000
    s_cbranch_scc1 L_done
    buffer_load_dword v245, v200, s[48:51], 0 offen sc1
    s_waitcnt vmcnt(0)
    s_branch L_nonce0
L_nonce_ok0:
    v_or_b32 v88, v88, v96
    v_or_b32 v89, v89, v97
    v_or_b32 v90, v90, v98
    v_or_b32 v91, v91, v99
    v_or_b32 v92, v92, v100
    s_waitcnt lgkmcnt(0)
    v_add_lshl_u32 v104, v104, v112, 2
    ds_write_b32 v104, v88 offset:2048
    v_add_lshl_u32 v105, v105, v113, 2
    ds_write_b32 v105, v89 offset:2048
    v_add_lshl_u32 v106, v106, v114, 2
    ds_write_b32 v106, v90 offset:2048
    v_add_lshl_u32 v107, v107, v115, 2
    ds_write_b32 v107, v91 offset:2048
    v_add_lshl_u32 v108, v108, v116, 2
    s_mov_b64 exec, s[70:71]
    ds_write_b32 v108, v92 offset:2048
    s_mov_b64 exec, -1
    s_cmp_ge_u32 s29, 4
    s_cbranch_scc1 L_notab
    s_lshl_b32 s55, s28, 12
    s_add_u32 s55, s55, 2621440
    v_mov_b32 v147, s63
    buffer_store_dwordx4 v[144:147], v2, s[16:19], s55 offen sc1
L_notab:
    s_waitcnt lgkmcnt(0)
    s_barrier
    ds_read_b128 v[96:99], v2 offset:2048
    s_cmp_ge_u32 s29, 2
    s_cbranch_scc1 L_p1_no2
    ds_read_b128 v[100:103], v2 offset:10240
    s_waitcnt lgkmcnt(0)
    buffer_store_dwordx4 v[100:103], v2, s[16:19], s53 offen sc1
L_p1_no2:
    s_waitcnt lgkmcnt(0)
    buffer_store_dwordx4 v[96:99], v2, s[16:19], s52 offen sc1
    ds_read_b128 v[120:123], v160
    ds_read_b128 v[124:127], v161
    ds_read_b128 v[128:131], v162
    ds_read_b128 v[132:135], v163
    s_cmp_lt_u32 s29, 4
    s_cbranch_scc1 L_p1_nob
    ds_read_b64_tr_b16 v[168:169], v164 offset:8192
    ds_read_b64_tr_b16 v[170:171], v164 offset:8704
    ds_read_b64_tr_b16 v[172:173], v164 offset:10240
    ds_read_b64_tr_b16 v[174:175], v164 offset:10752
    ds_read_b64_tr_b16 v[176:177], v164 offset:12288
    ds_read_b64_tr_b16 v[178:179], v164 offset:12800
    ds_read_b64_tr_b16 v[180:181], v164 offset:14336
    ds_read_b64_tr_b16 v[182:183], v164 offset:14848
    s_waitcnt lgkmcnt(0)
    v_mfma_f32_32x32x16_bf16 v[56:71], v[168:171], v[120:123], 0
    v_mfma_f32_32x32x16_bf16 v[56:71], v[172:175], v[124:127], v[56:71]
    v_mfma_f32_32x32x16_bf16 v[56:71], v[176:179], v[128:131], v[56:71]
    v_mfma_f32_32x32x16_bf16 v[56:71], v[180:183], v[132:135], v[56:71]
    s_nop 15
    v_pk_mul_f32 v[56:57], v[56:57], s[86:87]
    v_pk_mul_f32 v[58:59], v[58:59], s[86:87]
    v_cvt_pk_bf16_f32 v56, v56, v57
    v_cvt_pk_bf16_f32 v57, v58, v59
    v_xor_b32 v9, 0, v167
    ds_write_b64 v9, v[56:57] offset:12288
    v_pk_mul_f32 v[60:61], v[60:61], s[86:87]
    v_pk_mul_f32 v[62:63], v[62:63], s[86:87]
    v_cvt_pk_bf16_f32 v60, v60, v61
    v_cvt_pk_bf16_f32 v61, v62, v63
    v_xor_b32 v9, 16, v167
    ds_write_b64 v9, v[60:61] offset:12288
    v_pk_mul_f32 v[64:65], v[64:65], s[86:87]
    v_pk_mul_f32 v[66:67], v[66:67], s[86:87]
    v_cvt_pk_bf16_f32 v64, v64, v65
    v_cvt_pk_bf16_f32 v65, v66, v67
    v_xor_b32 v9, 32, v167
    ds_write_b64 v9, v[64:65] offset:12288
    v_pk_mul_f32 v[68:69], v[68:69], s[86:87]
    v_pk_mul_f32 v[70:71], v[70:71], s[86:87]
    v_cvt_pk_bf16_f32 v68, v68, v69
    v_cvt_pk_bf16_f32 v69, v70, v71
    v_xor_b32 v9, 48, v167
    ds_write_b64 v9, v[68:69] offset:12288
    s_waitcnt vmcnt(5)
    s_branch L_p1_nob2
L_p1_nob:
    v_lshlrev_b32 v9, 3, v5
    v_sub_u32 v9, v4, v9
    v_lshlrev_b32 v10, 4, v6
    v_lshlrev_b32 v10, v10, v213
    v_lshrrev_b32 v9, 1, v9
    v_cmp_eq_u32 s[64:65], 0, v9
    v_cmp_eq_u32 s[66:67], 1, v9
    v_cmp_eq_u32 s[68:69], 2, v9
    v_cmp_eq_u32 s[70:71], 3, v9
    v_cndmask_b32 v16, 0, v10, s[64:65]
    v_cndmask_b32 v17, 0, v10, s[66:67]
    v_cndmask_b32 v18, 0, v10, s[68:69]
    v_cndmask_b32 v19, 0, v10, s[70:71]
    v_cmp_eq_u32 s[64:65], 8, v9
    v_cmp_eq_u32 s[66:67], 9, v9
    v_cmp_eq_u32 s[68:69], 10, v9
    v_cmp_eq_u32 s[70:71], 11, v9
    v_cndmask_b32 v20, 0, v10, s[64:65]
    v_cndmask_b32 v21, 0, v10, s[66:67]
    v_cndmask_b32 v22, 0, v10, s[68:69]
    v_cndmask_b32 v23, 0, v10, s[70:71]
    s_add_u32 m0, s84, 102400
    s_nop 0
    buffer_load_dwordx4 v3, s[8:11], s84 offen offset:0 lds
    buffer_load_dwordx4 v3, s[8:11], s84 offen offset:1024 lds
    s_add_u32 m0, s84, 102400
    s_nop 0
    buffer_load_dwordx4 v3, s[8:11], s84 offen offset:2048 lds
    buffer_load_dwordx4 v3, s[8:11], s84 offen offset:3072 lds
L_p1_nob2:
    s_lshl_b32 s54, s28, 4
    s_add_u32 s54, s54, 2621440
    s_lshl_b32 s79, s28, 8
    s_add_u32 s79, s79, 4950272
    v_lshlrev_b32 v219, 2, v1
    v_mov_b32 v243, s63
    s_lshl_b32 s57, s96, 7
    s_add_u32 s57, s57, 3667968
    s_sub_u32 s55, s29, 2
    s_cmp_ge_u32 s55, 5
    s_waitcnt lgkmcnt(0)
    s_barrier
    s_cbranch_scc1 L_nobst
    ds_read_b128 v[96:99], v166 offset:10240
    s_waitcnt lgkmcnt(0)
    buffer_store_dwordx4 v[96:99], v2, s[16:19], s57 offen sc1
L_nobst:
    s_cmp_ge_u32 s29, 4
    s_cbranch_scc1 L_w_a
    ds_read_b64_tr_b16 v[168:169], v164 offset:16384
    ds_read_b64_tr_b16 v[170:171], v164 offset:16896
    ds_read_b64_tr_b16 v[172:173], v164 offset:18432
    ds_read_b64_tr_b16 v[174:175], v164 offset:18944
    ds_read_b64_tr_b16 v[176:177], v164 offset:20480
    ds_read_b64_tr_b16 v[178:179], v164 offset:20992
    ds_read_b64_tr_b16 v[180:181], v164 offset:22528
    ds_read_b64_tr_b16 v[182:183], v164 offset:23040
    ds_read_b64_tr_b16 v[24:25], v164 offset:24576
    ds_read_b64_tr_b16 v[26:27], v164 offset:25088
    ds_read_b64_tr_b16 v[28:29], v164 offset:26624
    ds_read_b64_tr_b16 v[30:31], v164 offset:27136
    ds_read_b64_tr_b16 v[32:33], v164 offset:28672
    ds_read_b64_tr_b16 v[34:35], v164 offset:29184
    ds_read_b64_tr_b16 v[36:37], v164 offset:30720
    ds_read_b64_tr_b16 v[38:39], v164 offset:31232
    v_bfe_u32 v9, v0, 1, 3
    v_lshlrev_b32 v9, 4, v9
    s_lshl_b32 s57, s89, 6
    v_xor_b32 v9, s57, v9
    v_lshl_add_u32 v9, v4, 7, v9
    v_lshl_add_u32 v9, v5, 3, v9
    v_add_u32 v9, s59, v9
    v_xor_b32 v10, 0, v9
    ds_read_b64 v[40:41], v10
    v_xor_b32 v10, 16, v9
    ds_read_b64 v[42:43], v10
    v_xor_b32 v10, 32, v9
    ds_read_b64 v[44:45], v10
    v_xor_b32 v10, 48, v9
    ds_read_b64 v[46:47], v10
    s_waitcnt lgkmcnt(12)
    v_mfma_f32_32x32x16_bf16 v[224:239], v[168:171], v[120:123], 0
    v_mfma_f32_32x32x16_bf16 v[224:239], v[172:175], v[124:127], v[224:239]
    v_mfma_f32_32x32x16_bf16 v[224:239], v[176:179], v[128:131], v[224:239]
    v_mfma_f32_32x32x16_bf16 v[224:239], v[180:183], v[132:135], v[224:239]
    s_nop 15
    v_pk_mul_f32 v[224:225], v[224:225], s[86:87]
    v_pk_mul_f32 v[226:227], v[226:227], s[86:87]
    v_pk_mul_f32 v[228:229], v[228:229], s[86:87]
    v_pk_mul_f32 v[230:231], v[230:231], s[86:87]
    v_pk_mul_f32 v[232:233], v[232:233], s[86:87]
    v_pk_mul_f32 v[234:235], v[234:235], s[86:87]
    v_pk_mul_f32 v[236:237], v[236:237], s[86:87]
    v_pk_mul_f32 v[238:239], v[238:239], s[86:87]
    s_branch L_w_j
L_w_a:
    ds_read_b64_tr_b16 v[168:169], v164 offset:0
    ds_read_b64_tr_b16 v[170:171], v164 offset:512
    ds_read_b64_tr_b16 v[172:173], v164 offset:2048
    ds_read_b64_tr_b16 v[174:175], v164 offset:2560
    ds_read_b64_tr_b16 v[176:177], v164 offset:4096
    ds_read_b64_tr_b16 v[178:179], v164 offset:4608
    ds_read_b64_tr_b16 v[180:181], v164 offset:6144
    ds_read_b64_tr_b16 v[182:183], v164 offset:6656
    v_lshrrev_b32 v9, 3, v1
    v_and_b32 v10, 7, v1
    v_cmp_eq_u32 s[64:65], v9, v10
    s_lshl_b32 s57, s89, 9
    s_add_u32 s57, s57, s58
    v_cndmask_b32 v10, 0, v213, s[64:65]
    ds_write_b16 v8, v10 offset:0
    ds_write_b16 v8, v10 offset:128
    ds_write_b16 v8, v10 offset:256
    ds_write_b16 v8, v10 offset:384
    ds_write_b16 v8, v10 offset:512
    s_waitcnt lgkmcnt(5)
    v_mfma_f32_32x32x16_bf16 v[56:71], v[120:123], v[168:171], 0
    v_mfma_f32_32x32x16_bf16 v[56:71], v[124:127], v[172:175], v[56:71]
    v_mfma_f32_32x32x16_bf16 v[56:71], v[128:131], v[176:179], v[56:71]
    v_mfma_f32_32x32x16_bf16 v[56:71], v[132:135], v[180:183], v[56:71]
    v_lshl_add_u32 v9, v5, 3, v218
    v_add_u32 v9, s57, v9
    s_nop 13
    v_pk_mul_f32 v[56:57], v[56:57], s[86:87]
    v_pk_mul_f32 v[58:59], v[58:59], s[86:87]
    v_cvt_pk_bf16_f32 v56, v56, v57
    v_cvt_pk_bf16_f32 v57, v58, v59
    ds_write_b64 v9, v[56:57] offset:47104
    s_cmp_lg_u32 s88, 0
    s_cbranch_scc1 L_w_a2
    v_pk_mul_f32 v[60:61], v[60:61], s[86:87]
    v_pk_mul_f32 v[62:63], v[62:63], s[86:87]
    v_cvt_pk_bf16_f32 v60, v60, v61
    v_cvt_pk_bf16_f32 v61, v62, v63
    ds_write_b64 v9, v[60:61] offset:48128
    v_pk_mul_f32 v[64:65], v[64:65], s[86:87]
    v_pk_mul_f32 v[66:67], v[66:67], s[86:87]
    v_cvt_pk_bf16_f32 v64, v64, v65
    v_cvt_pk_bf16_f32 v65, v66, v67
    ds_write_b64 v9, v[64:65] offset:49152
    v_pk_mul_f32 v[68:69], v[68:69], s[86:87]
    v_pk_mul_f32 v[70:71], v[70:71], s[86:87]
    v_cvt_pk_bf16_f32 v68, v68, v69
    v_cvt_pk_bf16_f32 v69, v70, v71
    ds_write_b64 v9, v[68:69] offset:50176
L_w_a2:
    v_lshlrev_b32 v9, 3, v5
    v_sub_u32 v9, v4, v9
    v_lshlrev_b32 v10, 4, v6
    v_lshlrev_b32 v10, v10, v213
    v_lshrrev_b32 v9, 1, v9
    v_cmp_eq_u32 s[64:65], 0, v9
    v_cmp_eq_u32 s[66:67], 1, v9
    v_cmp_eq_u32 s[68:69], 2, v9
    v_cmp_eq_u32 s[70:71], 3, v9
    v_cndmask_b32 v16, 0, v10, s[64:65]
    v_cndmask_b32 v17, 0, v10, s[66:67]
    v_cndmask_b32 v18, 0, v10, s[68:69]
    v_cndmask_b32 v19, 0, v10, s[70:71]
    v_cmp_eq_u32 s[64:65], 8, v9
    v_cmp_eq_u32 s[66:67], 9, v9
    v_cmp_eq_u32 s[68:69], 10, v9
    v_cmp_eq_u32 s[70:71], 11, v9
    v_cndmask_b32 v20, 0, v10, s[64:65]
    v_cndmask_b32 v21, 0, v10, s[66:67]
    v_cndmask_b32 v22, 0, v10, s[68:69]
    v_cndmask_b32 v23, 0, v10, s[70:71]
L_w_j:
    s_waitcnt vmcnt(0)
    s_barrier
    s_cmp_lg_u32 s29, 0
    s_cbranch_scc1 L_noflag0
    s_mov_b64 exec, s[90:91]
    buffer_store_dword v243, v219, s[16:19], s79 offen offset:0 sc1
    s_mov_b64 exec, -1
L_noflag0:
    buffer_load_dwordx4 v[220:223], v13, s[16:19], s54 offen sc1
    s_mul_i32 s60, s29, 15
    v_add_u32 v10, s60, v1
    v_mul_u32_u24 v9, 171, v10
    v_lshrrev_b32 v9, 9, v9
    v_add_lshl_u32 v14, v9, v10, 2
    s_mov_b32 m0, 32768
    s_mov_b32 s57, 16384
    buffer_load_short_d16_hi v15, v8, s[8:11], s95 offen
    buffer_load_short_d16_hi v214, v165, s[24:27], 0 offen
    buffer_load_short_d16_hi v215, v165, s[24:27], 0 offen offset:64
    buffer_load_dwordx4 v3, s[40:43], s57 offen lds
    s_add_u32 m0, s85, 102400
    s_nop 0
    buffer_load_dwordx4 v3, s[8:11], s85 offen offset:0 lds
    buffer_load_dwordx4 v3, s[8:11], s85 offen offset:1024 lds
    s_add_u32 m0, s85, 102400
    s_nop 0
    buffer_load_dwordx4 v3, s[8:11], s85 offen offset:2048 lds
    buffer_load_dwordx4 v3, s[8:11], s85 offen offset:3072 lds
    s_cmp_lg_u32 s29, 7
    s_cbranch_scc1 L_w_n7
    v_mov_b32 v72, 0
    v_mov_b32 v73, 0
    v_mov_b32 v74, 0
    v_mov_b32 v75, 0
    v_mov_b32 v76, 0
    s_waitcnt vmcnt(4)
    ds_read_u16_d16_hi v72, v8 offset:32768
    ds_read_u16_d16_hi v73, v8 offset:32896
    ds_read_u16_d16_hi v74, v8 offset:33024
    ds_read_u16_d16_hi v75, v8 offset:33152
    ds_read_u16_d16_hi v76, v8 offset:33280
    s_waitcnt lgkmcnt(0)
    v_mul_f32 v73, s86, v73
    v_mul_f32 v74, s86, v74
    v_mul_f32 v75, s86, v75
    v_mul_f32 v76, s86, v76
    v_cvt_pk_bf16_f32 v80, v73, v74
    v_cvt_pk_bf16_f32 v81, v75, v76
    v_lshrrev_b32 v82, 16, v72
    v_xor_b32 v82, 0x8000, v82
    v_mov_b32 v83, 0
    ds_write_b128 v3, v[80:83] offset:52224
L_w_n7:
    s_mov_b32 s56, 0xf000f000
    s_waitcnt vmcnt(4)
L_poll:
    v_or3_b32 v9, v220, v221, v222
    v_xor_b32 v10, s63, v223
    v_and_or_b32 v9, v9, s56, v10
    v_cmpx_ne_u32 vcc, 0, v9
    s_cbranch_execz L_poll_ok
    buffer_load_dwordx4 v[220:223], v13, s[16:19], s54 offen sc1
    s_add_u32 s94, s94, 1
    s_cmp_gt_u32 s94, 40000
    s_cbranch_scc1 L_done
    s_waitcnt vmcnt(0)
    s_branch L_poll
L_poll_ok:
    s_mov_b64 exec, 0x7fff
    ds_write_b32 v14, v15 offset:640
    s_mov_b64 exec, -1
L2_round:
    v_and_b32 v11, 0xffff, v220
    v_lshl_add_u32 v151, v6, 2, v11
    v_subrev_u32 v8, s30, v240
    v_cmp_gt_u32 s[64:65], s31, v8
    v_lshrrev_b32 v7, 16, v222
    v_sub_u32 v149, v7, v151
    v_lshl_add_u32 v150, v151, 2, v12
    v_cndmask_b32 v149, 0, v149, s[64:65]
    s_mov_b32 s61, 4950272
    v_lshlrev_b32 v13, 8, v240
    v_alignbit_b32 v8, v221, v220, 16
    v_alignbit_b32 v9, v222, v221, 16
    v_sub_u32 v156, v8, v220
    v_sub_u32 v157, v9, v221
    v_lshrrev_b32 v10, 16, v9
    v_sub_u32 v10, v7, v10
    v_sub_u32 v11, v7, v11
    v_lshl_or_b32 v158, v11, 12, v10
    s_and_b32 s66, s64, 0x55555555
    s_and_b32 s67, s65, 0x55555555
    v_cndmask_b32 v156, 0, v156, s[66:67]
    v_cndmask_b32 v157, 0, v157, s[66:67]
    v_cndmask_b32 v158, 0, v158, s[66:67]
    s_nop 1
    v_add_u32_dpp v156, v156, v156 row_shr:1 row_mask:0xf bank_mask:0xf bound_ctrl:0
    v_add_u32_dpp v157, v157, v157 row_shr:1 row_mask:0xf bank_mask:0xf bound_ctrl:0
    v_add_u32_dpp v158, v158, v158 row_shr:1 row_mask:0xf bank_mask:0xf bound_ctrl:0
    v_add_u32_dpp v156, v156, v156 row_shr:2 row_mask:0xf bank_mask:0xf bound_ctrl:0
    v_add_u32_dpp v157, v157, v157 row_shr:2 row_mask:0xf bank_mask:0xf bound_ctrl:0
    v_add_u32_dpp v158, v158, v158 row_shr:2 row_mask:0xf bank_mask:0xf bound_ctrl:0
    v_add_u32_dpp v156, v156, v156 row_shr:4 row_mask:0xf bank_mask:0xf bound_ctrl:0
    v_add_u32_dpp v157, v157, v157 row_shr:4 row_mask:0xf bank_mask:0xf bound_ctrl:0
    v_add_u32_dpp v158, v158, v158 row_shr:4 row_mask:0xf bank_mask:0xf bound_ctrl:0
    v_add_u32_dpp v156, v156, v156 row_shr:8 row_mask:0xf bank_mask:0xf bound_ctrl:0
    v_add_u32_dpp v157, v157, v157 row_shr:8 row_mask:0xf bank_mask:0xf bound_ctrl:0
    v_add_u32_dpp v158, v158, v158 row_shr:8 row_mask:0xf bank_mask:0xf bound_ctrl:0
    v_add_u32_dpp v156, v156, v156 row_bcast:15 row_mask:0xa bank_mask:0xf
    v_add_u32_dpp v157, v157, v157 row_bcast:15 row_mask:0xa bank_mask:0xf
    v_add_u32_dpp v158, v158, v158 row_bcast:15 row_mask:0xa bank_mask:0xf
    v_add_u32_dpp v156, v156, v156 row_bcast:31 row_mask:0xc bank_mask:0xf
    v_add_u32_dpp v157, v157, v157 row_bcast:31 row_mask:0xc bank_mask:0xf
    v_add_u32_dpp v158, v158, v158 row_bcast:31 row_mask:0xc bank_mask:0xf
    s_lshl_b32 s52, s29, 4
    v_mov_b32 v10, s52
    s_mov_b32 exec_lo, 0
    s_mov_b32 exec_hi, 0x80000000
    ds_write_b64 v10, v[156:157] offset:1664
    ds_write_b32 v10, v158 offset:1672
    s_mov_b64 exec, -1
    v_lshl_or_b32 v10, v151, 16, v151
    v_sub_u32 v8, v10, v8
    v_sub_u32 v9, v10, v9
    v_add_u32 v156, v156, v8
    v_add_u32 v157, v157, v9
    v_and_b32 v158, 0xfff, v158
    v_sub_u32 v10, v151, v7
    v_add_u32 v158, v158, v10
    v_and_b32 v8, 7, v0
    v_lshlrev_b32 v8, 4, v8
    buffer_load_dword v245, v13, s[16:19], s61 offen sc1
    s_waitcnt lgkmcnt(0)
    s_barrier
    ds_read_b128 v[136:139], v8 offset:1664
    s_cmp_lg_u32 s30, 0
    s_cbranch_scc1 L2_nobk
    ds_read_b128 v[48:51], v218 offset:52224
    ds_read_b128 v[52:55], v218 offset:52736
L2_nobk:
    v_add_u32 v9, s78, v3
    ds_write_b128 v9, v[200:203]
    ds_write_b128 v9, v[200:203] offset:1024
    s_waitcnt lgkmcnt(2)
    v_mov_b32 v140, v136
    v_mov_b32 v141, v137
    v_mov_b32 v142, v138
    s_nop 0
    v_add_u32_dpp v140, v140, v140 row_shr:1 row_mask:0xf bank_mask:0xf bound_ctrl:0
    v_add_u32_dpp v141, v141, v141 row_shr:1 row_mask:0xf bank_mask:0xf bound_ctrl:0
    v_add_u32_dpp v142, v142, v142 row_shr:1 row_mask:0xf bank_mask:0xf bound_ctrl:0
    v_add_u32_dpp v140, v140, v140 row_shr:2 row_mask:0xf bank_mask:0xf bound_ctrl:0
    v_add_u32_dpp v141, v141, v141 row_shr:2 row_mask:0xf bank_mask:0xf bound_ctrl:0
    v_add_u32_dpp v142, v142, v142 row_shr:2 row_mask:0xf bank_mask:0xf bound_ctrl:0
    v_add_u32_dpp v140, v140, v140 row_shr:4 row_mask:0xf bank_mask:0xf bound_ctrl:0
    v_add_u32_dpp v141, v141, v141 row_shr:4 row_mask:0xf bank_mask:0xf bound_ctrl:0
    v_add_u32_dpp v142, v142, v142 row_shr:4 row_mask:0xf bank_mask:0xf bound_ctrl:0
    v_sub_u32 v136, v140, v136
    v_sub_u32 v137, v141, v137
    v_sub_u32 v138, v142, v138
    v_readlane_b32 s52, v140, 7
    v_readlane_b32 s53, v141, 7
    v_readlane_b32 s54, v142, 7
    v_readlane_b32 s55, v136, s29
    v_readlane_b32 s56, v137, s29
    v_readlane_b32 s57, v138, s29
L_poll2:
    s_waitcnt vmcnt(0)
    v_cmpx_ne_u32 vcc, s63, v245
    s_cbranch_execz L_poll2_ok
    buffer_load_dword v245, v13, s[16:19], s61 offen sc1
    s_add_u32 s94, s94, 1
    s_cmp_gt_u32 s94, 40000
    s_cbranch_scc1 L_done
    s_branch L_poll2
L_poll2_ok:
    s_mov_b64 exec, -1
    v_cmpx_lt_i32 vcc, 0, v149
    buffer_load_dwordx4 v[88:91], v150, s[16:19], 0 offen offset:0 sc1
    v_cmpx_lt_i32 vcc, 8, v149
    buffer_load_dwordx4 v[92:95], v150, s[16:19], 0 offen offset:32 sc1
    v_cmpx_lt_i32 vcc, 16, v149
    buffer_load_dwordx4 v[96:99], v150, s[16:19], 0 offen offset:64 sc1
    v_cmpx_lt_i32 vcc, 24, v149
    buffer_load_dwordx4 v[100:103], v150, s[16:19], 0 offen offset:96 sc1
    s_mov_b64 exec, -1
    s_lshr_b32 s58, s54, 12
    s_cmp_gt_u32 s58, 2816
    s_cbranch_scc1 L2_overflow
    s_and_b32 s38, s52, 0xffff
    s_lshr_b32 s39, s52, 16
    s_and_b32 s40, s53, 0xffff
    s_lshr_b32 s41, s53, 16
    s_and_b32 s42, s54, 0xfff
    s_add_u32 s33, s38, 31
    s_andn2_b32 s33, s33, 31
    s_add_u32 s39, s39, s33
    s_add_u32 s34, s39, 31
    s_andn2_b32 s34, s34, 31
    s_add_u32 s40, s40, s34
    s_add_u32 s35, s40, 31
    s_andn2_b32 s35, s35, 31
    s_add_u32 s41, s41, s35
    s_add_u32 s36, s41, 31
    s_andn2_b32 s36, s36, 31
    s_add_u32 s42, s42, s36
    s_add_u32 s37, s42, 31
    s_andn2_b32 s37, s37, 31
    s_cmp_gt_u32 s37, 2816
    s_cbranch_scc1 L2_overflow
    s_lshl_b32 s58, s33, 16
    s_add_u32 s55, s55, s58
    s_pack_ll_b32_b16 s58, s34, s35
    s_add_u32 s56, s56, s58
    s_and_b32 s57, s57, 0xfff
    s_add_u32 s57, s57, s36
    v_add_u32 v9, s55, v156
    v_add_u32 v10, s56, v157
    v_add_lshl_u32 v148, v158, s57, 3
    v_lshlrev_b32_sdwa v144, 3, v9 dst_sel:DWORD dst_unused:UNUSED_PAD src0_sel:DWORD src1_sel:WORD_0
    v_lshlrev_b32_sdwa v145, 3, v9 dst_sel:DWORD dst_unused:UNUSED_PAD src0_sel:DWORD src1_sel:WORD_1
    v_lshlrev_b32_sdwa v146, 3, v10 dst_sel:DWORD dst_unused:UNUSED_PAD src0_sel:DWORD src1_sel:WORD_0
    v_lshlrev_b32_sdwa v147, 3, v10 dst_sel:DWORD dst_unused:UNUSED_PAD src0_sel:DWORD src1_sel:WORD_1
    ds_write2st64_b32 v242, v144, v145 offset0:0 offset1:8
    ds_write2st64_b32 v242, v146, v147 offset0:16 offset1:24
    ds_write_b32 v242, v148 offset:8192
    s_cmp_ge_u32 s29, 5
    s_cbranch_scc1 L2_listinit
    s_mov_b32 m0, s29
    s_lshl_b32 s60, s29, 22
    s_movrels_b32 s58, s38
    s_movrels_b32 s59, s33
    s_add_u32 s60, s60, 10000
    v_add_u32 v8, s58, v1
    v_mov_b32 v10, 0x7ff00000
    v_mov_b32 v11, s60
    v_lshlrev_b32 v9, 3, v8
    v_cmpx_gt_u32 vcc, s59, v8
    ds_write_b64 v9, v[10:11] offset:2048
    s_mov_b64 exec, -1
    s_branch L2_nopad
L2_listinit:
    v_lshlrev_b32 v9, 2, v1
    v_mov_b32 v10, 53248
    ds_write_b32 v9, v10 offset:1792
    ds_write_b32 v200, v200 offset:1648
L2_nopad:
    s_lshr_b32 s33, s33, 5
    s_lshr_b32 s34, s34, 5
    s_lshr_b32 s35, s35, 5
    s_lshr_b32 s36, s36, 5
    s_lshr_b32 s37, s37, 5
    s_lshr_b32 s80, s37, 3
    s_and_b32 s81, s37, 7
    s_mul_i32 s44, s80, s29
    s_min_u32 s52, s29, s81
    s_add_u32 s44, s44, s52
    s_cmp_lt_u32 s29, s81
    s_addc_u32 s52, s80, 0
    s_add_u32 s45, s44, s52
    s_mul_i32 s82, s52, 52
    s_lshl_b32 s52, s52, 5
    s_lshl_b32 s53, s44, 8
    v_lshl_add_u32 v8, v1, 3, s53
    v_lshl_add_u32 v208, v4, 3, s53
    v_and_b32 v207, 0x38, v1
    v_add_u32 v207, s53, v207
    v_min_u32 v9, s81, v1
    v_mad_u32_u24 v9, v1, s80, v9
    s_mov_b32 s32, 0
    s_mov_b32 s43, 0
    s_mov_b64 exec, 0xfe
    v_cmp_ge_u32 vcc, s32, v9
    s_bcnt1_i32_b32 s64, vcc_lo
    v_cmp_ge_u32 vcc, s33, v9
    s_bcnt1_i32_b32 s65, vcc_lo
    v_cmp_ge_u32 vcc, s34, v9
    s_bcnt1_i32_b32 s66, vcc_lo
    v_cmp_ge_u32 vcc, s35, v9
    s_bcnt1_i32_b32 s67, vcc_lo
    v_cmp_ge_u32 vcc, s36, v9
    s_bcnt1_i32_b32 s68, vcc_lo
    s_mov_b64 exec, -1
    s_mov_b32 s74, 0xffff0000
    s_mov_b32 s70, 0
    s_lshr_b32 s73, s82, 6
    s_add_u32 s73, s73, s44
    s_cmp_lt_u32 s29, 4
    s_cselect_b32 s73, -1, s73
    s_cmp_lt_u32 s29, 4
    s_cselect_b32 s82, 2, -1
    s_cselect_b32 s53, s44, 0
    s_add_u32 s82, s82, s53
    s_mov_b32 s62, s44
    s_mov_b32 s47, 0
    s_cmp_ge_u32 s62, s33
    s_addc_u32 s47, s47, 0
    s_cmp_ge_u32 s62, s34
    s_addc_u32 s47, s47, 0
    s_cmp_ge_u32 s62, s35
    s_addc_u32 s47, s47, 0
    s_cmp_ge_u32 s62, s36
    s_addc_u32 s47, s47, 0
    s_cmp_ge_u32 s62, s37
    s_addc_u32 s47, s47, 0
    s_mov_b32 m0, s47
    s_lshl_b32 s53, s47, 10
    s_movrels_b32 s49, s33
    s_movrels_b32 s50, s38
    v_add_u32 v219, s53, v218
    v_mul_u32_u24 v210, s47, v212
    v_sub_u32 v210, v211, v210
    s_mov_b64 exec, s[90:91]
    ds_read_b128 v[48:51], v219 offset:47104
    ds_read_b128 v[52:55], v219 offset:47616
    s_mov_b64 exec, -1
L2_h920_a:
    s_lshl_b32 s54, s62, 5
    s_sub_i32 s54, s50, s54
    s_bfm_b32 s71, s54, 0
    s_cmp_ge_i32 s54, 32
    s_cselect_b32 s71, -1, s71
    s_cmp_ge_u32 s62, s45
    s_cselect_b32 s71, 0, s71
    s_sub_u32 s72, s49, 1
    s_cmp_gt_u32 s72, s62
    s_cselect_b32 s72, s72, s49
    s_min_u32 s72, s72, s45
    s_cmp_gt_u32 s73, s62
    s_cbranch_scc1 L2_h920_b
    s_setprio 0
    s_mov_b32 s73, -1
L2_h920_b:
    s_min_u32 s72, s72, s73
    s_min_u32 s72, s72, s82
    s_mov_b32 s46, s47
    s_mov_b32 s48, s47
    v_mfma_f32_32x32x16_bf16 v[152:167], v[200:203], v[200:203], 0
    v_mov_b32 v10, 0x0000bf80
    v_mov_b32 v11, 0xbf800000
    s_mov_b32 s54, 102400
    s_waitcnt vmcnt(0)
L2_place:
    v_bfe_u32 v169, v88, 14, 6
    v_lshrrev_b32 v136, 3, v169
    v_lshl_add_u32 v136, v136, 11, v242
    ds_read_b32 v136, v136
    v_bfe_u32 v171, v89, 14, 6
    v_lshrrev_b32 v137, 3, v171
    v_lshl_add_u32 v137, v137, 11, v242
    ds_read_b32 v137, v137
    v_bfe_u32 v173, v90, 14, 6
    v_lshrrev_b32 v138, 3, v173
    v_lshl_add_u32 v138, v138, 11, v242
    ds_read_b32 v138, v138
    v_bfe_u32 v175, v91, 14, 6
    v_lshrrev_b32 v139, 3, v175
    v_lshl_add_u32 v139, v139, 11, v242
    ds_read_b32 v139, v139
    v_bfe_u32 v177, v92, 14, 6
    v_lshrrev_b32 v140, 3, v177
    v_lshl_add_u32 v140, v140, 11, v242
    ds_read_b32 v140, v140
    v_bfe_u32 v179, v93, 14, 6
    v_lshrrev_b32 v141, 3, v179
    v_lshl_add_u32 v141, v141, 11, v242
    ds_read_b32 v141, v141
    v_bfe_u32 v181, v94, 14, 6
    v_lshrrev_b32 v142, 3, v181
    v_lshl_add_u32 v142, v142, 11, v242
    ds_read_b32 v142, v142
    v_bfe_u32 v183, v95, 14, 6
    v_lshrrev_b32 v143, 3, v183
    v_lshl_add_u32 v143, v143, 11, v242
    ds_read_b32 v143, v143
    v_lshrrev_b32 v168, 20, v88
    v_and_b32 v88, 16383, v88
    v_lshl_add_u32 v168, v168, 3, v241
    v_lshl_or_b32 v169, v169, 19, v88
    v_lshrrev_b32 v170, 20, v89
    v_and_b32 v89, 16383, v89
    v_lshl_add_u32 v170, v170, 3, v241
    v_lshl_or_b32 v171, v171, 19, v89
    v_lshrrev_b32 v172, 20, v90
    v_and_b32 v90, 16383, v90
    v_lshl_add_u32 v172, v172, 3, v241
    v_lshl_or_b32 v173, v173, 19, v90
    v_lshrrev_b32 v174, 20, v91
    v_and_b32 v91, 16383, v91
    v_lshl_add_u32 v174, v174, 3, v241
    v_lshl_or_b32 v175, v175, 19, v91
    v_lshrrev_b32 v176, 20, v92
    v_and_b32 v92, 16383, v92
    v_lshl_add_u32 v176, v176, 3, v241
    v_lshl_or_b32 v177, v177, 19, v92
    v_lshrrev_b32 v178, 20, v93
    v_and_b32 v93, 16383, v93
    v_lshl_add_u32 v178, v178, 3, v241
    v_lshl_or_b32 v179, v179, 19, v93
    v_lshrrev_b32 v180, 20, v94
    v_and_b32 v94, 16383, v94
    v_lshl_add_u32 v180, v180, 3, v241
    v_lshl_or_b32 v181, v181, 19, v94
    v_lshrrev_b32 v182, 20, v95
    v_and_b32 v95, 16383, v95
    v_lshl_add_u32 v182, v182, 3, v241
    v_lshl_or_b32 v183, v183, 19, v95
    s_waitcnt lgkmcnt(0)
    v_cmpx_lt_i32 vcc, 0, v149
    ds_write_b64 v136, v[168:169] offset:2048
    v_cmpx_lt_i32 vcc, 1, v149
    ds_write_b64 v137, v[170:171] offset:2056
    v_cmpx_lt_i32 vcc, 2, v149
    ds_write_b64 v138, v[172:173] offset:2064
    v_cmpx_lt_i32 vcc, 3, v149
    ds_write_b64 v139, v[174:175] offset:2072
    v_cmpx_lt_i32 vcc, 8, v149
    ds_write_b64 v140, v[176:177] offset:2112
    v_cmpx_lt_i32 vcc, 9, v149
    ds_write_b64 v141, v[178:179] offset:2120
    v_cmpx_lt_i32 vcc, 10, v149
    ds_write_b64 v142, v[180:181] offset:2128
    v_cmpx_lt_i32 vcc, 11, v149
    ds_write_b64 v143, v[182:183] offset:2136
    s_mov_b64 exec, -1
    v_cmp_lt_i32 vcc, 16, v149
    s_cbranch_vccz L2_placed
    v_bfe_u32 v169, v96, 14, 6
    v_lshrrev_b32 v136, 3, v169
    v_lshl_add_u32 v136, v136, 11, v242
    ds_read_b32 v136, v136
    v_bfe_u32 v171, v97, 14, 6
    v_lshrrev_b32 v137, 3, v171
    v_lshl_add_u32 v137, v137, 11, v242
    ds_read_b32 v137, v137
    v_bfe_u32 v173, v98, 14, 6
    v_lshrrev_b32 v138, 3, v173
    v_lshl_add_u32 v138, v138, 11, v242
    ds_read_b32 v138, v138
    v_bfe_u32 v175, v99, 14, 6
    v_lshrrev_b32 v139, 3, v175
    v_lshl_add_u32 v139, v139, 11, v242
    ds_read_b32 v139, v139
    v_lshrrev_b32 v168, 20, v96
    v_and_b32 v96, 16383, v96
    v_lshl_add_u32 v168, v168, 3, v241
    v_lshl_or_b32 v169, v169, 19, v96
    v_lshrrev_b32 v170, 20, v97
    v_and_b32 v97, 16383, v97
    v_lshl_add_u32 v170, v170, 3, v241
    v_lshl_or_b32 v171, v171, 19, v97
    v_lshrrev_b32 v172, 20, v98
    v_and_b32 v98, 16383, v98
    v_lshl_add_u32 v172, v172, 3, v241
    v_lshl_or_b32 v173, v173, 19, v98
    v_lshrrev_b32 v174, 20, v99
    v_and_b32 v99, 16383, v99
    v_lshl_add_u32 v174, v174, 3, v241
    v_lshl_or_b32 v175, v175, 19, v99
    s_waitcnt lgkmcnt(0)
    v_cmpx_lt_i32 vcc, 16, v149
    ds_write_b64 v136, v[168:169] offset:2176
    v_cmpx_lt_i32 vcc, 17, v149
    ds_write_b64 v137, v[170:171] offset:2184
    v_cmpx_lt_i32 vcc, 18, v149
    ds_write_b64 v138, v[172:173] offset:2192
    v_cmpx_lt_i32 vcc, 19, v149
    ds_write_b64 v139, v[174:175] offset:2200
    s_mov_b64 exec, -1
    v_cmp_lt_i32 vcc, 24, v149
    s_cbranch_vccz L2_placed
    v_bfe_u32 v169, v100, 14, 6
    v_lshrrev_b32 v136, 3, v169
    v_lshl_add_u32 v136, v136, 11, v242
    ds_read_b32 v136, v136
    v_bfe_u32 v171, v101, 14, 6
    v_lshrrev_b32 v137, 3, v171
    v_lshl_add_u32 v137, v137, 11, v242
    ds_read_b32 v137, v137
    v_bfe_u32 v173, v102, 14, 6
    v_lshrrev_b32 v138, 3, v173
    v_lshl_add_u32 v138, v138, 11, v242
    ds_read_b32 v138, v138
    v_bfe_u32 v175, v103, 14, 6
    v_lshrrev_b32 v139, 3, v175
    v_lshl_add_u32 v139, v139, 11, v242
    ds_read_b32 v139, v139
    v_lshrrev_b32 v168, 20, v100
    v_and_b32 v100, 16383, v100
    v_lshl_add_u32 v168, v168, 3, v241
    v_lshl_or_b32 v169, v169, 19, v100
    v_lshrrev_b32 v170, 20, v101
    v_and_b32 v101, 16383, v101
    v_lshl_add_u32 v170, v170, 3, v241
    v_lshl_or_b32 v171, v171, 19, v101
    v_lshrrev_b32 v172, 20, v102
    v_and_b32 v102, 16383, v102
    v_lshl_add_u32 v172, v172, 3, v241
    v_lshl_or_b32 v173, v173, 19, v102
    v_lshrrev_b32 v174, 20, v103
    v_and_b32 v103, 16383, v103
    v_lshl_add_u32 v174, v174, 3, v241
    v_lshl_or_b32 v175, v175, 19, v103
    s_waitcnt lgkmcnt(0)
    v_cmpx_lt_i32 vcc, 24, v149
    ds_write_b64 v136, v[168:169] offset:2240
    v_cmpx_lt_i32 vcc, 25, v149
    ds_write_b64 v137, v[170:171] offset:2248
    v_cmpx_lt_i32 vcc, 26, v149
    ds_write_b64 v138, v[172:173] offset:2256
    v_cmpx_lt_i32 vcc, 27, v149
    ds_write_b64 v139, v[174:175] offset:2264
    s_mov_b64 exec, -1
    v_cmp_lt_i32 vcc, 32, v149
    s_cbranch_vccz L2_placed
    v_subrev_u32 v149, 32, v149
    v_add_u32 v150, 128, v150
    v_cmpx_lt_i32 vcc, 0, v149
    buffer_load_dwordx4 v[88:91], v150, s[16:19], 0 offen offset:0 sc1
    v_cmpx_lt_i32 vcc, 8, v149
    buffer_load_dwordx4 v[92:95], v150, s[16:19], 0 offen offset:32 sc1
    v_cmpx_lt_i32 vcc, 16, v149
    buffer_load_dwordx4 v[96:99], v150, s[16:19], 0 offen offset:64 sc1
    v_cmpx_lt_i32 vcc, 24, v149
    buffer_load_dwordx4 v[100:103], v150, s[16:19], 0 offen offset:96 sc1
    s_mov_b64 exec, -1
    v_add_u32 v144, 256, v144
    v_add_u32 v145, 256, v145
    v_add_u32 v146, 256, v146
    v_add_u32 v147, 256, v147
    v_add_u32 v148, 256, v148
    ds_write2st64_b32 v242, v144, v145 offset0:0 offset1:8
    ds_write2st64_b32 v242, v146, v147 offset0:16 offset1:24
    ds_write_b32 v242, v148 offset:8192
    s_waitcnt vmcnt(0)
    s_branch L2_place
L2_placed:
    s_waitcnt lgkmcnt(0)
    s_barrier
    ds_read_u16 v184, v207 offset:2052
    ds_read_u16 v186, v207 offset:2116
    ds_read_u16 v188, v207 offset:2180
    ds_read_u16 v190, v207 offset:2244
    ds_read_b64 v[196:197], v208 offset:2048
    ds_read_b64 v[198:199], v208 offset:2304
    s_cmp_ge_u32 s29, 4
    s_cbranch_scc1 L2_cv_y
    ds_read_b32 v88, v8 offset:2052
    v_mfma_f32_32x32x16_bf16 v[56:71], v[200:203], v[200:203], 0
    v_mfma_f32_32x32x16_bf16 v[72:87], v[200:203], v[200:203], 0
    s_waitcnt lgkmcnt(0)
    v_mad_u32_u16 v89, v88, 6, s54
    v_and_b32 v89, -4, v89
    ds_read2_b32 v[90:91], v89 offset0:0 offset1:1
    v_lshrrev_b32 v89, 15, v88
    v_and_b32 v89, 0x3f0, v89
    ds_read_b128 v[92:95], v89 offset:640
    v_lshlrev_b32 v88, 4, v88
    s_mov_b64 exec, s[92:93]
    buffer_load_dwordx2 v[136:137], v196, s[12:15], 0 offen
    s_mov_b64 exec, -1
    s_add_u32 m0, s75, 0
    s_nop 0
    buffer_load_dwordx4 v[184:185], s[20:23], 0 idxen offen sc1 lds
    s_add_u32 m0, s75, 1024
    s_nop 0
    buffer_load_dwordx4 v[186:187], s[20:23], 0 idxen offen sc1 lds
    s_add_u32 m0, s75, 2048
    s_nop 0
    buffer_load_dwordx4 v[188:189], s[20:23], 0 idxen offen sc1 lds
    s_add_u32 m0, s75, 3072
    s_nop 0
    buffer_load_dwordx4 v[190:191], s[20:23], 0 idxen offen sc1 lds
    ds_read_u16 v184, v207 offset:2308
    ds_read_u16 v186, v207 offset:2372
    ds_read_u16 v188, v207 offset:2436
    ds_read_u16 v190, v207 offset:2500
    s_waitcnt lgkmcnt(4)
    v_alignbit_b32 v89, v91, v90, v88
    v_lshrrev_b32 v95, v88, v91
    v_dot2_f32_bf16 v92, v89, v10, v92
    v_dot2_f32_bf16 v93, v89, v11, v93
    v_dot2_f32_bf16 v94, v95, v10, v94
    v_mov_b32 v243, 1
    s_mov_b64 exec, 1
    ds_add_u32 v200, v243 offset:1648
    s_mov_b64 exec, -1
L2_cv_o:
    s_nop 1
    v_mul_f32 v89, v92, v92
    v_fmac_f32 v89, v93, v93
    v_fmac_f32 v89, v94, v94
    v_cvt_pk_bf16_f32 v91, v93, v94
    v_mul_f32 v89, 0x3fb8aa3b, v89
    v_cvt_pk_bf16_f32 v90, v89, v92
    ds_write_b64 v8, v[90:91] offset:24576
    s_lshl_b32 s95, s96, 7
    v_lshl_add_u32 v9, s88, 5, v4
    s_lshl_b32 s59, s89, 6
    s_add_u32 s95, s95, s59
    v_lshlrev_b32 v13, 3, v5
    v_lshl_add_u32 v13, v9, 7, v13
    v_lshrrev_b32 v14, 3, v9
    v_lshlrev_b32 v14, 5, v14
    v_and_b32 v11, 7, v9
    v_mul_u32_u24 v11, 144, v11
    v_lshl_add_u32 v11, v5, 4, v11
    s_mov_b32 s24, s76
    s_mov_b32 s25, s77
    s_mov_b32 s26, 1280000
    s_mov_b32 s27, 0x20000
    s_branch L2_cv_j
L2_cv_y:
    v_lshlrev_b32 v8, 3, v0
    v_subrev_u32 v8, 2048, v8
    ds_read_b32 v88, v8 offset:2052
    ds_read_b32 v96, v8 offset:4100
    ds_read_b32 v104, v8 offset:6148
    ds_read_b32 v112, v8 offset:8196
    ds_read_b32 v168, v8 offset:10244
    ds_read_b32 v176, v8 offset:12292
    ds_read_b32 v56, v8 offset:14340
    ds_read_b32 v64, v8 offset:16388
    ds_read_b32 v72, v8 offset:18436
    ds_read_b32 v80, v8 offset:20484
    ds_read_b32 v120, v8 offset:22532
    s_waitcnt lgkmcnt(5)
    v_mad_u32_u16 v89, v88, 6, s54
    v_and_b32 v89, -4, v89
    ds_read2_b32 v[90:91], v89 offset0:0 offset1:1
    v_lshrrev_b32 v89, 15, v88
    ds_read_b128 v[92:95], v89 offset:640
    v_lshlrev_b32 v88, 4, v88
    v_mad_u32_u16 v97, v96, 6, s54
    v_and_b32 v97, -4, v97
    ds_read2_b32 v[98:99], v97 offset0:0 offset1:1
    v_lshrrev_b32 v97, 15, v96
    ds_read_b128 v[100:103], v97 offset:640
    v_lshlrev_b32 v96, 4, v96
    v_mad_u32_u16 v105, v104, 6, s54
    v_and_b32 v105, -4, v105
    ds_read2_b32 v[106:107], v105 offset0:0 offset1:1
    v_lshrrev_b32 v105, 15, v104
    ds_read_b128 v[108:111], v105 offset:640
    v_lshlrev_b32 v104, 4, v104
    v_mad_u32_u16 v113, v112, 6, s54
    v_and_b32 v113, -4, v113
    ds_read2_b32 v[114:115], v113 offset0:0 offset1:1
    v_lshrrev_b32 v113, 15, v112
    ds_read_b128 v[116:119], v113 offset:640
    v_lshlrev_b32 v112, 4, v112
    v_mad_u32_u16 v169, v168, 6, s54
    v_and_b32 v169, -4, v169
    ds_read2_b32 v[170:171], v169 offset0:0 offset1:1
    v_lshrrev_b32 v169, 15, v168
    ds_read_b128 v[172:175], v169 offset:640
    v_lshlrev_b32 v168, 4, v168
    v_mad_u32_u16 v177, v176, 6, s54
    v_and_b32 v177, -4, v177
    ds_read2_b32 v[178:179], v177 offset0:0 offset1:1
    v_lshrrev_b32 v177, 15, v176
    ds_read_b128 v[180:183], v177 offset:640
    v_lshlrev_b32 v176, 4, v176
    s_waitcnt lgkmcnt(10)
    v_alignbit_b32 v89, v91, v90, v88
    v_lshrrev_b32 v95, v88, v91
    v_dot2_f32_bf16 v92, v89, v10, v92
    v_dot2_f32_bf16 v93, v89, v11, v93
    v_dot2_f32_bf16 v94, v95, v10, v94
    s_waitcnt lgkmcnt(8)
    v_alignbit_b32 v97, v99, v98, v96
    v_lshrrev_b32 v103, v96, v99
    v_dot2_f32_bf16 v100, v97, v10, v100
    v_dot2_f32_bf16 v101, v97, v11, v101
    v_dot2_f32_bf16 v102, v103, v10, v102
    s_waitcnt lgkmcnt(6)
    v_alignbit_b32 v105, v107, v106, v104
    v_lshrrev_b32 v111, v104, v107
    v_dot2_f32_bf16 v108, v105, v10, v108
    v_dot2_f32_bf16 v109, v105, v11, v109
    v_dot2_f32_bf16 v110, v111, v10, v110
    s_waitcnt lgkmcnt(4)
    v_alignbit_b32 v113, v115, v114, v112
    v_lshrrev_b32 v119, v112, v115
    v_dot2_f32_bf16 v116, v113, v10, v116
    v_dot2_f32_bf16 v117, v113, v11, v117
    v_dot2_f32_bf16 v118, v119, v10, v118
    s_waitcnt lgkmcnt(2)
    v_alignbit_b32 v169, v171, v170, v168
    v_lshrrev_b32 v175, v168, v171
    v_dot2_f32_bf16 v172, v169, v10, v172
    v_dot2_f32_bf16 v173, v169, v11, v173
    v_dot2_f32_bf16 v174, v175, v10, v174
    s_waitcnt lgkmcnt(0)
    v_alignbit_b32 v177, v179, v178, v176
    v_lshrrev_b32 v183, v176, v179
    v_dot2_f32_bf16 v180, v177, v10, v180
    v_dot2_f32_bf16 v181, v177, v11, v181
    v_dot2_f32_bf16 v182, v183, v10, v182
    v_mul_f32 v89, v92, v92
    v_fmac_f32 v89, v93, v93
    v_fmac_f32 v89, v94, v94
    v_cvt_pk_bf16_f32 v91, v93, v94
    v_mul_f32 v89, 0x3fb8aa3b, v89
    v_cvt_pk_bf16_f32 v90, v89, v92
    ds_write_b64 v8, v[90:91] offset:24576
    v_mul_f32 v97, v100, v100
    v_fmac_f32 v97, v101, v101
    v_fmac_f32 v97, v102, v102
    v_cvt_pk_bf16_f32 v99, v101, v102
    v_mul_f32 v97, 0x3fb8aa3b, v97
    v_cvt_pk_bf16_f32 v98, v97, v100
    ds_write_b64 v8, v[98:99] offset:26624
    v_mul_f32 v105, v108, v108
    v_fmac_f32 v105, v109, v109
    v_fmac_f32 v105, v110, v110
    v_cvt_pk_bf16_f32 v107, v109, v110
    v_mul_f32 v105, 0x3fb8aa3b, v105
    v_cvt_pk_bf16_f32 v106, v105, v108
    ds_write_b64 v8, v[106:107] offset:28672
    v_mul_f32 v113, v116, v116
    v_fmac_f32 v113, v117, v117
    v_fmac_f32 v113, v118, v118
    v_cvt_pk_bf16_f32 v115, v117, v118
    v_mul_f32 v113, 0x3fb8aa3b, v113
    v_cvt_pk_bf16_f32 v114, v113, v116
    ds_write_b64 v8, v[114:115] offset:30720
    v_mul_f32 v169, v172, v172
    v_fmac_f32 v169, v173, v173
    v_fmac_f32 v169, v174, v174
    v_cvt_pk_bf16_f32 v171, v173, v174
    v_mul_f32 v169, 0x3fb8aa3b, v169
    v_cvt_pk_bf16_f32 v170, v169, v172
    ds_write_b64 v8, v[170:171] offset:32768
    v_mul_f32 v177, v180, v180
    v_fmac_f32 v177, v181, v181
    v_fmac_f32 v177, v182, v182
    v_cvt_pk_bf16_f32 v179, v181, v182
    v_mul_f32 v177, 0x3fb8aa3b, v177
    v_cvt_pk_bf16_f32 v178, v177, v180
    ds_write_b64 v8, v[178:179] offset:34816
    s_mov_b64 exec, -1
    s_waitcnt lgkmcnt(6)
    v_mad_u32_u16 v57, v56, 6, s54
    v_and_b32 v57, -4, v57
    ds_read2_b32 v[58:59], v57 offset0:0 offset1:1
    v_lshrrev_b32 v57, 15, v56
    ds_read_b128 v[60:63], v57 offset:640
    v_lshlrev_b32 v56, 4, v56
    v_mad_u32_u16 v65, v64, 6, s54
    v_and_b32 v65, -4, v65
    ds_read2_b32 v[66:67], v65 offset0:0 offset1:1
    v_lshrrev_b32 v65, 15, v64
    ds_read_b128 v[68:71], v65 offset:640
    v_lshlrev_b32 v64, 4, v64
    v_mad_u32_u16 v73, v72, 6, s54
    v_and_b32 v73, -4, v73
    ds_read2_b32 v[74:75], v73 offset0:0 offset1:1
    v_lshrrev_b32 v73, 15, v72
    v_and_b32 v73, 0x3f0, v73
    ds_read_b128 v[76:79], v73 offset:640
    v_lshlrev_b32 v72, 4, v72
    v_mad_u32_u16 v81, v80, 6, s54
    v_and_b32 v81, -4, v81
    ds_read2_b32 v[82:83], v81 offset0:0 offset1:1
    v_lshrrev_b32 v81, 15, v80
    v_and_b32 v81, 0x3f0, v81
    ds_read_b128 v[84:87], v81 offset:640
    v_lshlrev_b32 v80, 4, v80
    v_mad_u32_u16 v121, v120, 6, s54
    v_and_b32 v121, -4, v121
    ds_read2_b32 v[122:123], v121 offset0:0 offset1:1
    v_lshrrev_b32 v121, 15, v120
    v_and_b32 v121, 0x3f0, v121
    ds_read_b128 v[124:127], v121 offset:640
    v_lshlrev_b32 v120, 4, v120
    s_waitcnt lgkmcnt(8)
    v_alignbit_b32 v57, v59, v58, v56
    v_lshrrev_b32 v63, v56, v59
    v_dot2_f32_bf16 v60, v57, v10, v60
    v_dot2_f32_bf16 v61, v57, v11, v61
    v_dot2_f32_bf16 v62, v63, v10, v62
    s_waitcnt lgkmcnt(6)
    v_alignbit_b32 v65, v67, v66, v64
    v_lshrrev_b32 v71, v64, v67
    v_dot2_f32_bf16 v68, v65, v10, v68
    v_dot2_f32_bf16 v69, v65, v11, v69
    v_dot2_f32_bf16 v70, v71, v10, v70
    s_waitcnt lgkmcnt(4)
    v_alignbit_b32 v73, v75, v74, v72
    v_lshrrev_b32 v79, v72, v75
    v_dot2_f32_bf16 v76, v73, v10, v76
    v_dot2_f32_bf16 v77, v73, v11, v77
    v_dot2_f32_bf16 v78, v79, v10, v78
    s_waitcnt lgkmcnt(2)
    v_alignbit_b32 v81, v83, v82, v80
    v_lshrrev_b32 v87, v80, v83
    v_dot2_f32_bf16 v84, v81, v10, v84
    v_dot2_f32_bf16 v85, v81, v11, v85
    v_dot2_f32_bf16 v86, v87, v10, v86
    s_waitcnt lgkmcnt(0)
    v_alignbit_b32 v121, v123, v122, v120
    v_lshrrev_b32 v127, v120, v123
    v_dot2_f32_bf16 v124, v121, v10, v124
    v_dot2_f32_bf16 v125, v121, v11, v125
    v_dot2_f32_bf16 v126, v127, v10, v126
    v_mul_f32 v57, v60, v60
    v_fmac_f32 v57, v61, v61
    v_fmac_f32 v57, v62, v62
    v_cvt_pk_bf16_f32 v59, v61, v62
    v_mul_f32 v57, 0x3fb8aa3b, v57
    v_cvt_pk_bf16_f32 v58, v57, v60
    ds_write_b64 v8, v[58:59] offset:36864
    v_mul_f32 v65, v68, v68
    v_fmac_f32 v65, v69, v69
    v_fmac_f32 v65, v70, v70
    v_cvt_pk_bf16_f32 v67, v69, v70
    v_mul_f32 v65, 0x3fb8aa3b, v65
    v_cvt_pk_bf16_f32 v66, v65, v68
    ds_write_b64 v8, v[66:67] offset:38912
    v_mul_f32 v73, v76, v76
    v_fmac_f32 v73, v77, v77
    v_fmac_f32 v73, v78, v78
    v_cvt_pk_bf16_f32 v75, v77, v78
    v_mul_f32 v73, 0x3fb8aa3b, v73
    v_cvt_pk_bf16_f32 v74, v73, v76
    ds_write_b64 v8, v[74:75] offset:40960
    v_mul_f32 v81, v84, v84
    v_fmac_f32 v81, v85, v85
    v_fmac_f32 v81, v86, v86
    v_cvt_pk_bf16_f32 v83, v85, v86
    v_mul_f32 v81, 0x3fb8aa3b, v81
    v_cvt_pk_bf16_f32 v82, v81, v84
    ds_write_b64 v8, v[82:83] offset:43008
    v_mul_f32 v121, v124, v124
    v_fmac_f32 v121, v125, v125
    v_fmac_f32 v121, v126, v126
    v_cvt_pk_bf16_f32 v123, v125, v126
    v_mul_f32 v121, 0x3fb8aa3b, v121
    v_cvt_pk_bf16_f32 v122, v121, v124
    ds_write_b64 v8, v[122:123] offset:45056
    s_mov_b64 exec, -1
    v_mov_b32 v243, 1
    s_mov_b64 exec, 1
    ds_add_u32 v200, v243 offset:1648
    s_mov_b64 exec, -1
    s_mov_b64 exec, s[92:93]
    buffer_load_dwordx2 v[136:137], v196, s[12:15], 0 offen
    s_mov_b64 exec, -1
    s_add_u32 m0, s75, 0
    s_nop 0
    buffer_load_dwordx4 v[184:185], s[20:23], 0 idxen offen sc1 lds
    s_add_u32 m0, s75, 1024
    s_nop 0
    buffer_load_dwordx4 v[186:187], s[20:23], 0 idxen offen sc1 lds
    s_add_u32 m0, s75, 2048
    s_nop 0
    buffer_load_dwordx4 v[188:189], s[20:23], 0 idxen offen sc1 lds
    s_add_u32 m0, s75, 3072
    s_nop 0
    buffer_load_dwordx4 v[190:191], s[20:23], 0 idxen offen sc1 lds
    ds_read_u16 v184, v207 offset:2308
    ds_read_u16 v186, v207 offset:2372
    ds_read_u16 v188, v207 offset:2436
    ds_read_u16 v190, v207 offset:2500
    v_mfma_f32_32x32x16_bf16 v[56:71], v[200:203], v[200:203], 0
    v_mfma_f32_32x32x16_bf16 v[72:87], v[200:203], v[200:203], 0
    v_subrev_u32 v14, 256, v0
    v_min_u32 v14, 127, v14
    v_mul_u32_u24 v7, 171, v14
    v_lshrrev_b32 v7, 9, v7
    v_mul_u32_u24 v8, 3, v7
    v_sub_u32 v8, v14, v8
    v_bfe_u32 v9, v7, 1, 2
    v_mad_u32_u24 v9, v9, 3, v8
    v_lshrrev_b32 v10, 1, v9
    v_lshlrev_b32 v10, 8, v10
    v_and_b32 v11, 1, v7
    v_lshl_add_u32 v10, v11, 7, v10
    v_and_b32 v11, 1, v9
    v_lshl_add_u32 v10, v11, 6, v10
    v_add_lshl_u32 v11, v7, v14, 2
    v_lshrrev_b32 v13, 3, v7
    v_lshlrev_b32 v13, 5, v13
    s_add_u32 s24, s76, 1280000
    s_addc_u32 s25, s77, 0
    s_mov_b32 s26, 60000
    s_mov_b32 s27, 0x20000
    s_mul_i32 s95, s96, 6
L2_cw1515:
    ds_read_b32 v219, v200 offset:1648
    s_add_u32 s94, s94, 1
    s_cmp_gt_u32 s94, 4000000
    s_cbranch_scc1 L_done
    s_waitcnt lgkmcnt(0)
    v_readfirstlane_b32 s55, v219
    s_cmp_lt_u32 s55, 8
    s_cbranch_scc1 L2_cw1515
    s_mov_b32 s82, -1
L2_cv_j:
    s_mov_b64 exec, s[92:93]
    buffer_load_dwordx2 v[140:141], v198, s[12:15], 0 offen
    s_mov_b64 exec, -1
L2_cv_k:
    v_mad_u32_u16 v204, v197, v209, v210 op_sel:[1,0,0,0]
    s_cmp_ge_u32 s44, s45
    s_cbranch_scc1 L2_empty
    ds_read_b64 v[138:139], v208 offset:24576
    s_mov_b64 exec, s[90:91]
    ds_read_b128 v[136:139], v204
    s_mov_b64 exec, -1
    s_cmp_eq_u32 s73, -1
    s_cbranch_scc1 L2_noprio
    s_setprio 1
L2_noprio:
    s_waitcnt vmcnt(1)
    ds_read_b128 v[120:123], v192
    ds_read_b128 v[124:127], v193
    ds_read_b128 v[128:131], v194
    ds_read_b128 v[132:135], v195
    s_waitcnt lgkmcnt(4)
    v_mfma_f32_32x32x16_bf16 v[88:103], v[136:139], v[48:51], 0
    v_and_or_b32 v243, v138, s74, v213
    s_waitcnt lgkmcnt(3)
    v_mfma_f32_32x32x16_bf16 v[88:103], v[120:123], v[16:19], v[88:103]
    s_waitcnt lgkmcnt(2)
    v_mfma_f32_32x32x16_bf16 v[88:103], v[124:127], v[20:23], v[88:103]
    s_waitcnt lgkmcnt(0)
    s_mov_b64 exec, s[70:71]
    ds_write2_b32 v204, v243, v139 offset0:0 offset1:1
    s_mov_b64 exec, -1
    s_add_u32 m0, s75, 0
    s_nop 0
    buffer_load_dwordx4 v[184:185], s[20:23], 0 idxen offen sc1 lds
    s_add_u32 m0, s75, 1024
    s_nop 0
    buffer_load_dwordx4 v[186:187], s[20:23], 0 idxen offen sc1 lds
    s_add_u32 m0, s75, 2048
    s_nop 0
    buffer_load_dwordx4 v[188:189], s[20:23], 0 idxen offen sc1 lds
    s_add_u32 m0, s75, 3072
    s_nop 0
    buffer_load_dwordx4 v[190:191], s[20:23], 0 idxen offen sc1 lds
    buffer_load_dword v15, v200, s[12:15], 0 offen
    .p2align 6
L2_loop:
    v_mfma_f32_32x32x16_bf16 v[104:119], v[136:139], v[52:55], 0
    v_exp_f32 v168, v88
    s_add_u32 s62, s44, 1
    v_exp_f32 v169, v89
    s_cmp_eq_u32 s62, s72
    v_exp_f32 v170, v90
    v_mfma_f32_32x32x16_bf16 v[104:119], v[128:131], v[16:19], v[104:119]
    s_cbranch_scc1 L2_ev0
L2_evr0:
    v_exp_f32 v171, v91
    ds_read_b64 v[196:197], v208 offset:2560
    v_exp_f32 v172, v92
    ds_read_u16 v184, v207 offset:2564
    v_exp_f32 v173, v93
    v_mfma_f32_32x32x16_bf16 v[104:119], v[132:135], v[20:23], v[104:119]
    v_mad_u32_u16 v205, v199, v209, v210 op_sel:[1,0,0,0]
    v_exp_f32 v174, v94
    ds_read_u16 v186, v207 offset:2628
    v_exp_f32 v175, v95
    ds_read_u16 v188, v207 offset:2692
    v_exp_f32 v176, v96
    ds_read_u16 v190, v207 offset:2756
    v_exp_f32 v177, v97
    ds_read_b64 v[142:143], v208 offset:24832
    v_exp_f32 v178, v98
    s_mov_b64 exec, s[90:91]
    ds_read_b128 v[140:143], v205
    s_mov_b64 exec, -1
    v_exp_f32 v179, v99
    s_waitcnt vmcnt(1)
    v_exp_f32 v180, v100
    ds_read_b128 v[120:123], v192
    v_exp_f32 v181, v101
    ds_read_b128 v[124:127], v193
    v_exp_f32 v182, v102
    ds_read_b128 v[128:131], v194
    v_exp_f32 v183, v103
    ds_read_b128 v[132:135], v195
    v_pk_add_f32 v[168:169], v[168:169], 1.0 op_sel_hi:[1,0]
    v_pk_add_f32 v[170:171], v[170:171], 1.0 op_sel_hi:[1,0]
    v_pk_add_f32 v[172:173], v[172:173], 1.0 op_sel_hi:[1,0]
    v_pk_add_f32 v[174:175], v[174:175], 1.0 op_sel_hi:[1,0]
    v_pk_add_f32 v[176:177], v[176:177], 1.0 op_sel_hi:[1,0]
    v_pk_add_f32 v[178:179], v[178:179], 1.0 op_sel_hi:[1,0]
    v_pk_add_f32 v[180:181], v[180:181], 1.0 op_sel_hi:[1,0]
    v_pk_add_f32 v[182:183], v[182:183], 1.0 op_sel_hi:[1,0]
    v_mfma_f32_32x32x16_bf16 v[72:87], v[152:155], v[160:163], v[72:87]
    v_rcp_f32 v168, v168
    v_rcp_f32 v169, v169
    v_rcp_f32 v170, v170
    v_mfma_f32_32x32x16_bf16 v[72:87], v[156:159], v[164:167], v[72:87]
    v_rcp_f32 v171, v171
    s_mov_b32 m0, s75
    v_rcp_f32 v172, v172
    s_waitcnt lgkmcnt(0)
    buffer_load_dwordx4 v[184:185], s[20:23], 0 idxen offen sc1 lds
    s_add_u32 m0, s75, 1024
    v_rcp_f32 v173, v173
    buffer_load_dwordx4 v[186:187], s[20:23], 0 idxen offen sc1 lds
    s_add_u32 m0, s75, 2048
    v_rcp_f32 v174, v174
    buffer_load_dwordx4 v[188:189], s[20:23], 0 idxen offen sc1 lds
    s_add_u32 m0, s75, 3072
    v_rcp_f32 v175, v175
    buffer_load_dwordx4 v[190:191], s[20:23], 0 idxen offen sc1 lds
    v_rcp_f32 v176, v176
    ds_read_b64_tr_b16 v[152:153], v206 offset:0
    v_rcp_f32 v177, v177
    ds_read_b64_tr_b16 v[154:155], v206 offset:512
    v_rcp_f32 v178, v178
    ds_read_b64_tr_b16 v[156:157], v206 offset:1024
    v_rcp_f32 v179, v179
    ds_read_b64_tr_b16 v[158:159], v206 offset:1536
    v_rcp_f32 v180, v180
    v_and_or_b32 v243, v142, s74, v213
    v_rcp_f32 v181, v181
    s_mov_b64 exec, s[92:93]
    buffer_load_dwordx2 v[136:137], v196, s[12:15], 0 offen
    ds_write_b64 v204, v[200:201]
    s_mov_b64 exec, s[70:71]
    ds_write2_b32 v205, v243, v143 offset0:0 offset1:1
    s_mov_b64 exec, -1
    v_rcp_f32 v182, v182
    s_cmp_lg_u32 s46, s48
    v_rcp_f32 v183, v183
    v_add_u32 v208, 256, v208
    v_add_u32 v207, 256, v207
    v_pk_mul_f32 v[168:169], v[168:169], v[88:89]
    v_pk_mul_f32 v[170:171], v[170:171], v[90:91]
    v_pk_mul_f32 v[172:173], v[172:173], v[92:93]
    v_pk_mul_f32 v[174:175], v[174:175], v[94:95]
    v_pk_mul_f32 v[176:177], v[176:177], v[96:97]
    v_pk_mul_f32 v[178:179], v[178:179], v[98:99]
    v_pk_mul_f32 v[180:181], v[180:181], v[100:101]
    v_pk_mul_f32 v[182:183], v[182:183], v[102:103]
    v_cvt_pk_bf16_f32 v144, v168, v169
    v_cvt_pk_bf16_f32 v145, v170, v171
    v_cvt_pk_bf16_f32 v146, v172, v173
    v_cvt_pk_bf16_f32 v147, v174, v175
    v_cvt_pk_bf16_f32 v148, v176, v177
    v_cvt_pk_bf16_f32 v149, v178, v179
    v_cvt_pk_bf16_f32 v150, v180, v181
    v_cvt_pk_bf16_f32 v151, v182, v183
    s_cbranch_scc1 L2_fl0
L2_flr0:
    v_mfma_f32_32x32x16_bf16 v[88:103], v[120:123], v[16:19], 0
    v_exp_f32 v168, v104
    s_mov_b32 s46, s47
    v_exp_f32 v169, v105
    s_mov_b32 s44, s62
    v_exp_f32 v170, v106
    v_mfma_f32_32x32x16_bf16 v[88:103], v[124:127], v[20:23], v[88:103]
    v_exp_f32 v171, v107
    v_exp_f32 v172, v108
    v_exp_f32 v173, v109
    v_exp_f32 v174, v110
    v_exp_f32 v175, v111
    v_exp_f32 v176, v112
    s_waitcnt vmcnt(5)
    v_mfma_f32_32x32x16_bf16 v[88:103], v[140:143], v[48:51], v[88:103]
    v_exp_f32 v177, v113
    v_exp_f32 v178, v114
    v_exp_f32 v179, v115
    v_exp_f32 v180, v116
    v_exp_f32 v181, v117
    v_exp_f32 v182, v118
    v_exp_f32 v183, v119
    s_waitcnt lgkmcnt(0)
    v_pk_add_f32 v[168:169], v[168:169], 1.0 op_sel_hi:[1,0]
    v_pk_add_f32 v[170:171], v[170:171], 1.0 op_sel_hi:[1,0]
    v_pk_add_f32 v[172:173], v[172:173], 1.0 op_sel_hi:[1,0]
    v_pk_add_f32 v[174:175], v[174:175], 1.0 op_sel_hi:[1,0]
    v_pk_add_f32 v[176:177], v[176:177], 1.0 op_sel_hi:[1,0]
    v_pk_add_f32 v[178:179], v[178:179], 1.0 op_sel_hi:[1,0]
    v_pk_add_f32 v[180:181], v[180:181], 1.0 op_sel_hi:[1,0]
    v_pk_add_f32 v[182:183], v[182:183], 1.0 op_sel_hi:[1,0]
    v_mfma_f32_32x32x16_bf16 v[56:71], v[152:155], v[144:147], v[56:71]
    v_rcp_f32 v168, v168
    v_rcp_f32 v169, v169
    v_rcp_f32 v170, v170
    v_mfma_f32_32x32x16_bf16 v[56:71], v[156:159], v[148:151], v[56:71]
    v_rcp_f32 v171, v171
    v_rcp_f32 v172, v172
    v_rcp_f32 v173, v173
    v_rcp_f32 v174, v174
    v_rcp_f32 v175, v175
    v_rcp_f32 v176, v176
    v_rcp_f32 v177, v177
    v_rcp_f32 v178, v178
    v_rcp_f32 v179, v179
    v_rcp_f32 v180, v180
    v_rcp_f32 v181, v181
    v_rcp_f32 v182, v182
    v_rcp_f32 v183, v183
    s_cmp_ge_u32 s44, s45
    v_pk_mul_f32 v[168:169], v[168:169], v[104:105]
    v_pk_mul_f32 v[170:171], v[170:171], v[106:107]
    v_pk_mul_f32 v[172:173], v[172:173], v[108:109]
    v_pk_mul_f32 v[174:175], v[174:175], v[110:111]
    v_pk_mul_f32 v[176:177], v[176:177], v[112:113]
    v_pk_mul_f32 v[178:179], v[178:179], v[114:115]
    v_pk_mul_f32 v[180:181], v[180:181], v[116:117]
    v_pk_mul_f32 v[182:183], v[182:183], v[118:119]
    v_cvt_pk_bf16_f32 v160, v168, v169
    v_cvt_pk_bf16_f32 v161, v170, v171
    v_cvt_pk_bf16_f32 v162, v172, v173
    v_cvt_pk_bf16_f32 v163, v174, v175
    v_cvt_pk_bf16_f32 v164, v176, v177
    v_cvt_pk_bf16_f32 v165, v178, v179
    v_cvt_pk_bf16_f32 v166, v180, v181
    v_cvt_pk_bf16_f32 v167, v182, v183
    s_cbranch_scc1 L2_tail
    v_mfma_f32_32x32x16_bf16 v[104:119], v[140:143], v[52:55], 0
    v_exp_f32 v168, v88
    s_add_u32 s62, s44, 1
    v_exp_f32 v169, v89
    s_cmp_eq_u32 s62, s72
    v_exp_f32 v170, v90
    v_mfma_f32_32x32x16_bf16 v[104:119], v[128:131], v[16:19], v[104:119]
    s_cbranch_scc1 L2_ev1
L2_evr1:
    v_exp_f32 v171, v91
    ds_read_b64 v[198:199], v208 offset:2560
    v_exp_f32 v172, v92
    ds_read_u16 v184, v207 offset:2564
    v_exp_f32 v173, v93
    v_mfma_f32_32x32x16_bf16 v[104:119], v[132:135], v[20:23], v[104:119]
    v_mad_u32_u16 v204, v197, v209, v210 op_sel:[1,0,0,0]
    v_exp_f32 v174, v94
    ds_read_u16 v186, v207 offset:2628
    v_exp_f32 v175, v95
    ds_read_u16 v188, v207 offset:2692
    v_exp_f32 v176, v96
    ds_read_u16 v190, v207 offset:2756
    v_exp_f32 v177, v97
    ds_read_b64 v[138:139], v208 offset:24832
    v_exp_f32 v178, v98
    s_mov_b64 exec, s[90:91]
    ds_read_b128 v[136:139], v204
    s_mov_b64 exec, -1
    v_exp_f32 v179, v99
    s_waitcnt vmcnt(1)
    v_exp_f32 v180, v100
    ds_read_b128 v[120:123], v192
    v_exp_f32 v181, v101
    ds_read_b128 v[124:127], v193
    v_exp_f32 v182, v102
    ds_read_b128 v[128:131], v194
    v_exp_f32 v183, v103
    ds_read_b128 v[132:135], v195
    v_pk_add_f32 v[168:169], v[168:169], 1.0 op_sel_hi:[1,0]
    v_pk_add_f32 v[170:171], v[170:171], 1.0 op_sel_hi:[1,0]
    v_pk_add_f32 v[172:173], v[172:173], 1.0 op_sel_hi:[1,0]
    v_pk_add_f32 v[174:175], v[174:175], 1.0 op_sel_hi:[1,0]
    v_pk_add_f32 v[176:177], v[176:177], 1.0 op_sel_hi:[1,0]
    v_pk_add_f32 v[178:179], v[178:179], 1.0 op_sel_hi:[1,0]
    v_pk_add_f32 v[180:181], v[180:181], 1.0 op_sel_hi:[1,0]
    v_pk_add_f32 v[182:183], v[182:183], 1.0 op_sel_hi:[1,0]
    v_mfma_f32_32x32x16_bf16 v[72:87], v[152:155], v[160:163], v[72:87]
    v_rcp_f32 v168, v168
    v_rcp_f32 v169, v169
    v_rcp_f32 v170, v170
    v_mfma_f32_32x32x16_bf16 v[72:87], v[156:159], v[164:167], v[72:87]
    v_rcp_f32 v171, v171
    s_mov_b32 m0, s75
    v_rcp_f32 v172, v172
    s_waitcnt lgkmcnt(0)
    buffer_load_dwordx4 v[184:185], s[20:23], 0 idxen offen sc1 lds
    s_add_u32 m0, s75, 1024
    v_rcp_f32 v173, v173
    buffer_load_dwordx4 v[186:187], s[20:23], 0 idxen offen sc1 lds
    s_add_u32 m0, s75, 2048
    v_rcp_f32 v174, v174
    buffer_load_dwordx4 v[188:189], s[20:23], 0 idxen offen sc1 lds
    s_add_u32 m0, s75, 3072
    v_rcp_f32 v175, v175
    buffer_load_dwordx4 v[190:191], s[20:23], 0 idxen offen sc1 lds
    v_rcp_f32 v176, v176
    ds_read_b64_tr_b16 v[152:153], v206 offset:0
    v_rcp_f32 v177, v177
    ds_read_b64_tr_b16 v[154:155], v206 offset:512
    v_rcp_f32 v178, v178
    ds_read_b64_tr_b16 v[156:157], v206 offset:1024
    v_rcp_f32 v179, v179
    ds_read_b64_tr_b16 v[158:159], v206 offset:1536
    v_rcp_f32 v180, v180
    v_and_or_b32 v243, v138, s74, v213
    v_rcp_f32 v181, v181
    s_mov_b64 exec, s[92:93]
    buffer_load_dwordx2 v[140:141], v198, s[12:15], 0 offen
    ds_write_b64 v205, v[200:201]
    s_mov_b64 exec, s[70:71]
    ds_write2_b32 v204, v243, v139 offset0:0 offset1:1
    s_mov_b64 exec, -1
    v_rcp_f32 v182, v182
    s_cmp_lg_u32 s46, s48
    v_rcp_f32 v183, v183
    v_add_u32 v208, 256, v208
    v_add_u32 v207, 256, v207
    v_pk_mul_f32 v[168:169], v[168:169], v[88:89]
    v_pk_mul_f32 v[170:171], v[170:171], v[90:91]
    v_pk_mul_f32 v[172:173], v[172:173], v[92:93]
    v_pk_mul_f32 v[174:175], v[174:175], v[94:95]
    v_pk_mul_f32 v[176:177], v[176:177], v[96:97]
    v_pk_mul_f32 v[178:179], v[178:179], v[98:99]
    v_pk_mul_f32 v[180:181], v[180:181], v[100:101]
    v_pk_mul_f32 v[182:183], v[182:183], v[102:103]
    v_cvt_pk_bf16_f32 v144, v168, v169
    v_cvt_pk_bf16_f32 v145, v170, v171
    v_cvt_pk_bf16_f32 v146, v172, v173
    v_cvt_pk_bf16_f32 v147, v174, v175
    v_cvt_pk_bf16_f32 v148, v176, v177
    v_cvt_pk_bf16_f32 v149, v178, v179
    v_cvt_pk_bf16_f32 v150, v180, v181
    v_cvt_pk_bf16_f32 v151, v182, v183
    s_cbranch_scc1 L2_fl1
L2_flr1:
    v_mfma_f32_32x32x16_bf16 v[88:103], v[120:123], v[16:19], 0
    v_exp_f32 v168, v104
    s_mov_b32 s46, s47
    v_exp_f32 v169, v105
    s_mov_b32 s44, s62
    v_exp_f32 v170, v106
    v_mfma_f32_32x32x16_bf16 v[88:103], v[124:127], v[20:23], v[88:103]
    v_exp_f32 v171, v107
    v_exp_f32 v172, v108
    v_exp_f32 v173, v109
    v_exp_f32 v174, v110
    v_exp_f32 v175, v111
    v_exp_f32 v176, v112
    s_waitcnt vmcnt(5)
    v_mfma_f32_32x32x16_bf16 v[88:103], v[136:139], v[48:51], v[88:103]
    v_exp_f32 v177, v113
    v_exp_f32 v178, v114
    v_exp_f32 v179, v115
    v_exp_f32 v180, v116
    v_exp_f32 v181, v117
    v_exp_f32 v182, v118
    v_exp_f32 v183, v119
    s_waitcnt lgkmcnt(0)
    v_pk_add_f32 v[168:169], v[168:169], 1.0 op_sel_hi:[1,0]
    v_pk_add_f32 v[170:171], v[170:171], 1.0 op_sel_hi:[1,0]
    v_pk_add_f32 v[172:173], v[172:173], 1.0 op_sel_hi:[1,0]
    v_pk_add_f32 v[174:175], v[174:175], 1.0 op_sel_hi:[1,0]
    v_pk_add_f32 v[176:177], v[176:177], 1.0 op_sel_hi:[1,0]
    v_pk_add_f32 v[178:179], v[178:179], 1.0 op_sel_hi:[1,0]
    v_pk_add_f32 v[180:181], v[180:181], 1.0 op_sel_hi:[1,0]
    v_pk_add_f32 v[182:183], v[182:183], 1.0 op_sel_hi:[1,0]
    v_mfma_f32_32x32x16_bf16 v[56:71], v[152:155], v[144:147], v[56:71]
    v_rcp_f32 v168, v168
    v_rcp_f32 v169, v169
    v_rcp_f32 v170, v170
    v_mfma_f32_32x32x16_bf16 v[56:71], v[156:159], v[148:151], v[56:71]
    v_rcp_f32 v171, v171
    v_rcp_f32 v172, v172
    v_rcp_f32 v173, v173
    v_rcp_f32 v174, v174
    v_rcp_f32 v175, v175
    v_rcp_f32 v176, v176
    v_rcp_f32 v177, v177
    v_rcp_f32 v178, v178
    v_rcp_f32 v179, v179
    v_rcp_f32 v180, v180
    v_rcp_f32 v181, v181
    v_rcp_f32 v182, v182
    v_rcp_f32 v183, v183
    s_cmp_ge_u32 s44, s45
    v_pk_mul_f32 v[168:169], v[168:169], v[104:105]
    v_pk_mul_f32 v[170:171], v[170:171], v[106:107]
    v_pk_mul_f32 v[172:173], v[172:173], v[108:109]
    v_pk_mul_f32 v[174:175], v[174:175], v[110:111]
    v_pk_mul_f32 v[176:177], v[176:177], v[112:113]
    v_pk_mul_f32 v[178:179], v[178:179], v[114:115]
    v_pk_mul_f32 v[180:181], v[180:181], v[116:117]
    v_pk_mul_f32 v[182:183], v[182:183], v[118:119]
    v_cvt_pk_bf16_f32 v160, v168, v169
    v_cvt_pk_bf16_f32 v161, v170, v171
    v_cvt_pk_bf16_f32 v162, v172, v173
    v_cvt_pk_bf16_f32 v163, v174, v175
    v_cvt_pk_bf16_f32 v164, v176, v177
    v_cvt_pk_bf16_f32 v165, v178, v179
    v_cvt_pk_bf16_f32 v166, v180, v181
    v_cvt_pk_bf16_f32 v167, v182, v183
    s_cbranch_scc0 L2_loop
L2_tail:
    s_nop 0
    v_mfma_f32_32x32x16_bf16 v[72:87], v[152:155], v[160:163], v[72:87]
    v_mfma_f32_32x32x16_bf16 v[72:87], v[156:159], v[164:167], v[72:87]
    s_setprio 0
    s_cmp_eq_u32 s82, -1
    s_cbranch_scc1 L2_tail_ok
L2_cw1923:
    ds_read_b32 v219, v200 offset:1648
    s_add_u32 s94, s94, 1
    s_cmp_gt_u32 s94, 4000000
    s_cbranch_scc1 L_done
    s_waitcnt lgkmcnt(0)
    v_readfirstlane_b32 s55, v219
    s_cmp_lt_u32 s55, 8
    s_cbranch_scc1 L2_cw1923
    s_mov_b32 s82, -1
L2_tail_ok:
    s_mul_i32 s53, s48, 2688
    s_mov_b32 m0, s48
    v_add_u32 v243, s53, v216
    s_movrels_b32 s54, s64
    v_add_u32 v219, s53, v217
    s_sub_u32 s54, s29, s54
    s_lshl3_add_u32 s54, s48, s54
    s_lshl_b32 s54, s54, 2
    v_mov_b32 v168, s54
    s_mov_b64 exec, 1
    ds_write_b32 v168, v219 offset:1792
    s_mov_b64 exec, -1
    v_cvt_pk_bf16_f32 v180, v56, v72
    ds_write_b16 v243, v180 offset:0
    ds_write_b16_d16_hi v243, v180 offset:64
    v_cvt_pk_bf16_f32 v181, v60, v76
    ds_write_b16 v243, v181 offset:288
    ds_write_b16_d16_hi v243, v181 offset:352
    v_cvt_pk_bf16_f32 v182, v64, v80
    ds_write_b16 v243, v182 offset:576
    ds_write_b16_d16_hi v243, v182 offset:640
    v_cvt_pk_bf16_f32 v183, v68, v84
    ds_write_b16 v243, v183 offset:864
    ds_write_b16_d16_hi v243, v183 offset:928
    s_branch L2_wave_done
L2_ev0:
    s_cmp_lt_u32 s62, s49
    s_cbranch_scc1 L2_h1960_a
    s_mov_b32 s47, 0
    s_cmp_ge_u32 s62, s33
    s_addc_u32 s47, s47, 0
    s_cmp_ge_u32 s62, s34
    s_addc_u32 s47, s47, 0
    s_cmp_ge_u32 s62, s35
    s_addc_u32 s47, s47, 0
    s_cmp_ge_u32 s62, s36
    s_addc_u32 s47, s47, 0
    s_cmp_ge_u32 s62, s37
    s_addc_u32 s47, s47, 0
    s_mov_b32 m0, s47
    s_lshl_b32 s53, s47, 10
    s_movrels_b32 s49, s33
    s_movrels_b32 s50, s38
    v_add_u32 v219, s53, v218
    v_mul_u32_u24 v210, s47, v212
    v_sub_u32 v210, v211, v210
    s_mov_b64 exec, s[90:91]
    ds_read_b128 v[48:51], v219 offset:47104
    ds_read_b128 v[52:55], v219 offset:47616
    s_mov_b64 exec, -1
L2_h1960_a:
    s_lshl_b32 s54, s62, 5
    s_sub_i32 s54, s50, s54
    s_bfm_b32 s71, s54, 0
    s_cmp_ge_i32 s54, 32
    s_cselect_b32 s71, -1, s71
    s_cmp_ge_u32 s62, s45
    s_cselect_b32 s71, 0, s71
    s_sub_u32 s72, s49, 1
    s_cmp_gt_u32 s72, s62
    s_cselect_b32 s72, s72, s49
    s_min_u32 s72, s72, s45
    s_cmp_gt_u32 s73, s62
    s_cbranch_scc1 L2_h1960_b
    s_setprio 0
    s_mov_b32 s73, -1
L2_h1960_b:
    s_min_u32 s72, s72, s73
    s_cmp_gt_u32 s82, s62
    s_cbranch_scc1 L2_h1960_c
L2_cw2004:
    ds_read_b32 v219, v200 offset:1648
    s_add_u32 s94, s94, 1
    s_cmp_gt_u32 s94, 4000000
    s_cbranch_scc1 L_done
    s_waitcnt lgkmcnt(0)
    v_readfirstlane_b32 s55, v219
    s_cmp_lt_u32 s55, 8
    s_cbranch_scc1 L2_cw2004
    s_mov_b32 s82, -1
L2_h1960_c:
    s_min_u32 s72, s72, s82
    s_branch L2_evr0
L2_fl0:
    s_mul_i32 s53, s48, 2688
    s_mov_b32 m0, s48
    v_add_u32 v243, s53, v216
    s_movrels_b32 s54, s64
    v_add_u32 v219, s53, v217
    s_sub_u32 s54, s29, s54
    s_lshl3_add_u32 s54, s48, s54
    s_lshl_b32 s54, s54, 2
    v_mov_b32 v168, s54
    s_mov_b64 exec, 1
    ds_write_b32 v168, v219 offset:1792
    s_mov_b64 exec, -1
    v_cvt_pk_bf16_f32 v180, v56, v72
    ds_write_b16 v243, v180 offset:0
    ds_write_b16_d16_hi v243, v180 offset:64
    v_cvt_pk_bf16_f32 v181, v60, v76
    ds_write_b16 v243, v181 offset:288
    ds_write_b16_d16_hi v243, v181 offset:352
    v_cvt_pk_bf16_f32 v182, v64, v80
    ds_write_b16 v243, v182 offset:576
    ds_write_b16_d16_hi v243, v182 offset:640
    v_cvt_pk_bf16_f32 v183, v68, v84
    ds_write_b16 v243, v183 offset:864
    ds_write_b16_d16_hi v243, v183 offset:928
    v_mul_f32 v168, v57, v214
    v_mul_f32 v169, v58, v214
    v_mul_f32 v170, v59, v214
    v_mul_f32 v171, v61, v214
    v_mul_f32 v172, v62, v214
    v_mul_f32 v173, v63, v214
    v_mul_f32 v174, v65, v214
    v_mul_f32 v175, v66, v214
    v_mul_f32 v176, v67, v214
    v_mul_f32 v177, v69, v214
    v_mul_f32 v178, v70, v214
    v_mul_f32 v179, v71, v214
    v_fmac_f32 v168, v73, v215
    v_fmac_f32 v169, v74, v215
    v_fmac_f32 v170, v75, v215
    v_fmac_f32 v171, v77, v215
    v_fmac_f32 v172, v78, v215
    v_fmac_f32 v173, v79, v215
    v_fmac_f32 v174, v81, v215
    v_fmac_f32 v175, v82, v215
    v_fmac_f32 v176, v83, v215
    v_fmac_f32 v177, v85, v215
    v_fmac_f32 v178, v86, v215
    v_fmac_f32 v179, v87, v215
    v_permlane16_swap_b32 v168, v169
    v_permlane16_swap_b32 v170, v171
    v_permlane16_swap_b32 v172, v173
    v_permlane16_swap_b32 v174, v175
    v_permlane16_swap_b32 v176, v177
    v_permlane16_swap_b32 v178, v179
    v_add_f32 v168, v168, v169
    v_add_f32 v170, v170, v171
    v_add_f32 v172, v172, v173
    v_add_f32 v174, v174, v175
    v_add_f32 v176, v176, v177
    v_add_f32 v178, v178, v179
    ds_write_b32 v219, v168 offset:1152
    ds_write_b32 v219, v170 offset:1408
    ds_write_b32 v219, v172 offset:1664
    ds_write_b32 v219, v174 offset:1920
    ds_write_b32 v219, v176 offset:2176
    ds_write_b32 v219, v178 offset:2432
    v_mfma_f32_32x32x16_bf16 v[56:71], v[200:203], v[200:203], 0
    v_mfma_f32_32x32x16_bf16 v[72:87], v[200:203], v[200:203], 0
    s_mov_b32 s48, s46
    s_branch L2_flr0
L2_ev1:
    s_cmp_lt_u32 s62, s49
    s_cbranch_scc1 L2_h2089_a
    s_mov_b32 s47, 0
    s_cmp_ge_u32 s62, s33
    s_addc_u32 s47, s47, 0
    s_cmp_ge_u32 s62, s34
    s_addc_u32 s47, s47, 0
    s_cmp_ge_u32 s62, s35
    s_addc_u32 s47, s47, 0
    s_cmp_ge_u32 s62, s36
    s_addc_u32 s47, s47, 0
    s_cmp_ge_u32 s62, s37
    s_addc_u32 s47, s47, 0
    s_mov_b32 m0, s47
    s_lshl_b32 s53, s47, 10
    s_movrels_b32 s49, s33
    s_movrels_b32 s50, s38
    v_add_u32 v219, s53, v218
    v_mul_u32_u24 v210, s47, v212
    v_sub_u32 v210, v211, v210
    s_mov_b64 exec, s[90:91]
    ds_read_b128 v[48:51], v219 offset:47104
    ds_read_b128 v[52:55], v219 offset:47616
    s_mov_b64 exec, -1
L2_h2089_a:
    s_lshl_b32 s54, s62, 5
    s_sub_i32 s54, s50, s54
    s_bfm_b32 s71, s54, 0
    s_cmp_ge_i32 s54, 32
    s_cselect_b32 s71, -1, s71
    s_cmp_ge_u32 s62, s45
    s_cselect_b32 s71, 0, s71
    s_sub_u32 s72, s49, 1
    s_cmp_gt_u32 s72, s62
    s_cselect_b32 s72, s72, s49
    s_min_u32 s72, s72, s45
    s_cmp_gt_u32 s73, s62
    s_cbranch_scc1 L2_h2089_b
    s_setprio 0
    s_mov_b32 s73, -1
L2_h2089_b:
    s_min_u32 s72, s72, s73
    s_cmp_gt_u32 s82, s62
    s_cbranch_scc1 L2_h2089_c
L2_cw2133:
    ds_read_b32 v219, v200 offset:1648
    s_add_u32 s94, s94, 1
    s_cmp_gt_u32 s94, 4000000
    s_cbranch_scc1 L_done
    s_waitcnt lgkmcnt(0)
    v_readfirstlane_b32 s55, v219
    s_cmp_lt_u32 s55, 8
    s_cbranch_scc1 L2_cw2133
    s_mov_b32 s82, -1
L2_h2089_c:
    s_min_u32 s72, s72, s82
    s_branch L2_evr1
L2_fl1:
    s_mul_i32 s53, s48, 2688
    s_mov_b32 m0, s48
    v_add_u32 v243, s53, v216
    s_movrels_b32 s54, s64
    v_add_u32 v219, s53, v217
    s_sub_u32 s54, s29, s54
    s_lshl3_add_u32 s54, s48, s54
    s_lshl_b32 s54, s54, 2
    v_mov_b32 v168, s54
    s_mov_b64 exec, 1
    ds_write_b32 v168, v219 offset:1792
    s_mov_b64 exec, -1
    v_cvt_pk_bf16_f32 v180, v56, v72
    ds_write_b16 v243, v180 offset:0
    ds_write_b16_d16_hi v243, v180 offset:64
    v_cvt_pk_bf16_f32 v181, v60, v76
    ds_write_b16 v243, v181 offset:288
    ds_write_b16_d16_hi v243, v181 offset:352
    v_cvt_pk_bf16_f32 v182, v64, v80
    ds_write_b16 v243, v182 offset:576
    ds_write_b16_d16_hi v243, v182 offset:640
    v_cvt_pk_bf16_f32 v183, v68, v84
    ds_write_b16 v243, v183 offset:864
    ds_write_b16_d16_hi v243, v183 offset:928
    v_mul_f32 v168, v57, v214
    v_mul_f32 v169, v58, v214
    v_mul_f32 v170, v59, v214
    v_mul_f32 v171, v61, v214
    v_mul_f32 v172, v62, v214
    v_mul_f32 v173, v63, v214
    v_mul_f32 v174, v65, v214
    v_mul_f32 v175, v66, v214
    v_mul_f32 v176, v67, v214
    v_mul_f32 v177, v69, v214
    v_mul_f32 v178, v70, v214
    v_mul_f32 v179, v71, v214
    v_fmac_f32 v168, v73, v215
    v_fmac_f32 v169, v74, v215
    v_fmac_f32 v170, v75, v215
    v_fmac_f32 v171, v77, v215
    v_fmac_f32 v172, v78, v215
    v_fmac_f32 v173, v79, v215
    v_fmac_f32 v174, v81, v215
    v_fmac_f32 v175, v82, v215
    v_fmac_f32 v176, v83, v215
    v_fmac_f32 v177, v85, v215
    v_fmac_f32 v178, v86, v215
    v_fmac_f32 v179, v87, v215
    v_permlane16_swap_b32 v168, v169
    v_permlane16_swap_b32 v170, v171
    v_permlane16_swap_b32 v172, v173
    v_permlane16_swap_b32 v174, v175
    v_permlane16_swap_b32 v176, v177
    v_permlane16_swap_b32 v178, v179
    v_add_f32 v168, v168, v169
    v_add_f32 v170, v170, v171
    v_add_f32 v172, v172, v173
    v_add_f32 v174, v174, v175
    v_add_f32 v176, v176, v177
    v_add_f32 v178, v178, v179
    ds_write_b32 v219, v168 offset:1152
    ds_write_b32 v219, v170 offset:1408
    ds_write_b32 v219, v172 offset:1664
    ds_write_b32 v219, v174 offset:1920
    ds_write_b32 v219, v176 offset:2176
    ds_write_b32 v219, v178 offset:2432
    v_mfma_f32_32x32x16_bf16 v[56:71], v[200:203], v[200:203], 0
    v_mfma_f32_32x32x16_bf16 v[72:87], v[200:203], v[200:203], 0
    s_mov_b32 s48, s46
    s_branch L2_flr1
L2_overflow:
    s_lshr_b32 s31, s31, 1
    s_cmp_eq_u32 s31, 0
    s_cbranch_scc1 L_done
    s_waitcnt vmcnt(0) lgkmcnt(0)
    s_barrier
    s_branch L2_round
L2_empty:
    v_mov_b32 v219, 163840
L2_wave_done:
    s_add_u32 s30, s30, s31
    s_mov_b32 s60, 53248
    s_cmp_ge_u32 s29, 4
    s_waitcnt lgkmcnt(0)
    s_barrier
    s_cbranch_scc1 L2_epi_pos
    ds_read_b128 v[160:163], v14 offset:1792
    ds_read_b128 v[164:167], v14 offset:1808
    v_mul_f32 v168, v57, v214
    v_mul_f32 v169, v58, v214
    v_mul_f32 v170, v59, v214
    v_mul_f32 v171, v61, v214
    v_mul_f32 v172, v62, v214
    v_mul_f32 v173, v63, v214
    v_mul_f32 v174, v65, v214
    v_mul_f32 v175, v66, v214
    v_mul_f32 v176, v67, v214
    v_mul_f32 v177, v69, v214
    v_mul_f32 v178, v70, v214
    v_mul_f32 v179, v71, v214
    v_fmac_f32 v168, v73, v215
    v_fmac_f32 v169, v74, v215
    s_waitcnt lgkmcnt(0)
    v_add_u32 v196, v160, v11
    ds_read_b128 v[88:91], v196 offset:0
    ds_read_b128 v[92:95], v196 offset:32
    ds_read_b128 v[96:99], v196 offset:64
    ds_read_b128 v[100:103], v196 offset:96
    v_add_u32 v197, v161, v11
    ds_read_b128 v[104:107], v197 offset:0
    ds_read_b128 v[108:111], v197 offset:32
    ds_read_b128 v[112:115], v197 offset:64
    ds_read_b128 v[116:119], v197 offset:96
    v_add_u32 v198, v162, v11
    ds_read_b128 v[120:123], v198 offset:0
    ds_read_b128 v[124:127], v198 offset:32
    ds_read_b128 v[128:131], v198 offset:64
    ds_read_b128 v[132:135], v198 offset:96
    v_max3_u32 v10, v163, v164, v165
    v_max3_u32 v10, v10, v166, v167
    v_cmp_ne_u32 vcc, s60, v10
    s_waitcnt lgkmcnt(11)
    v_mfma_f32_32x32x16_bf16 v[224:239], v[24:27], v[88:91], v[224:239]
    v_fmac_f32 v170, v75, v215
    v_fmac_f32 v171, v77, v215
    v_fmac_f32 v172, v78, v215
    v_fmac_f32 v173, v79, v215
    s_waitcnt lgkmcnt(10)
    v_mfma_f32_32x32x16_bf16 v[224:239], v[28:31], v[92:95], v[224:239]
    v_fmac_f32 v174, v81, v215
    v_fmac_f32 v175, v82, v215
    v_fmac_f32 v176, v83, v215
    v_fmac_f32 v177, v85, v215
    s_waitcnt lgkmcnt(9)
    v_mfma_f32_32x32x16_bf16 v[224:239], v[32:35], v[96:99], v[224:239]
    v_fmac_f32 v178, v86, v215
    v_fmac_f32 v179, v87, v215
    v_permlane16_swap_b32 v168, v169
    v_permlane16_swap_b32 v170, v171
    s_waitcnt lgkmcnt(8)
    v_mfma_f32_32x32x16_bf16 v[224:239], v[36:39], v[100:103], v[224:239]
    v_permlane16_swap_b32 v172, v173
    v_permlane16_swap_b32 v174, v175
    v_permlane16_swap_b32 v176, v177
    v_permlane16_swap_b32 v178, v179
    s_waitcnt lgkmcnt(7)
    v_mfma_f32_32x32x16_bf16 v[224:239], v[24:27], v[104:107], v[224:239]
    v_add_f32 v168, v168, v169
    v_add_f32 v170, v170, v171
    v_add_f32 v172, v172, v173
    v_add_f32 v174, v174, v175
    s_waitcnt lgkmcnt(6)
    v_mfma_f32_32x32x16_bf16 v[224:239], v[28:31], v[108:111], v[224:239]
    v_add_f32 v176, v176, v177
    v_add_f32 v178, v178, v179
    v_lshlrev_b32 v144, 16, v40
    v_and_b32 v145, 0xffff0000, v40
    s_waitcnt lgkmcnt(5)
    v_mfma_f32_32x32x16_bf16 v[224:239], v[32:35], v[112:115], v[224:239]
    v_lshlrev_b32 v146, 16, v41
    v_and_b32 v147, 0xffff0000, v41
    v_lshlrev_b32 v148, 16, v42
    v_and_b32 v149, 0xffff0000, v42
    s_waitcnt lgkmcnt(4)
    v_mfma_f32_32x32x16_bf16 v[224:239], v[36:39], v[116:119], v[224:239]
    v_lshlrev_b32 v150, 16, v43
    v_and_b32 v151, 0xffff0000, v43
    v_lshlrev_b32 v152, 16, v44
    v_and_b32 v153, 0xffff0000, v44
    s_waitcnt lgkmcnt(3)
    v_mfma_f32_32x32x16_bf16 v[224:239], v[24:27], v[120:123], v[224:239]
    v_lshlrev_b32 v154, 16, v45
    v_and_b32 v155, 0xffff0000, v45
    v_lshlrev_b32 v156, 16, v46
    v_and_b32 v157, 0xffff0000, v46
    s_waitcnt lgkmcnt(2)
    v_mfma_f32_32x32x16_bf16 v[224:239], v[28:31], v[124:127], v[224:239]
    v_lshlrev_b32 v158, 16, v47
    v_and_b32 v159, 0xffff0000, v47
    s_waitcnt lgkmcnt(1)
    v_mfma_f32_32x32x16_bf16 v[224:239], v[32:35], v[128:131], v[224:239]
    s_waitcnt lgkmcnt(0)
    v_mfma_f32_32x32x16_bf16 v[224:239], v[36:39], v[132:135], v[224:239]
    ds_write_b32 v219, v168 offset:1152
    ds_write_b32 v219, v170 offset:1408
    ds_write_b32 v219, v172 offset:1664
    ds_write_b32 v219, v174 offset:1920
    ds_write_b32 v219, v176 offset:2176
    ds_write_b32 v219, v178 offset:2432
    s_cbranch_vccz L2_mp_done
    v_add_u32 v196, v163, v11
    ds_read_b128 v[88:91], v196 offset:0
    ds_read_b128 v[92:95], v196 offset:32
    ds_read_b128 v[96:99], v196 offset:64
    ds_read_b128 v[100:103], v196 offset:96
    s_waitcnt lgkmcnt(3)
    v_mfma_f32_32x32x16_bf16 v[224:239], v[24:27], v[88:91], v[224:239]
    s_waitcnt lgkmcnt(2)
    v_mfma_f32_32x32x16_bf16 v[224:239], v[28:31], v[92:95], v[224:239]
    s_waitcnt lgkmcnt(1)
    v_mfma_f32_32x32x16_bf16 v[224:239], v[32:35], v[96:99], v[224:239]
    s_waitcnt lgkmcnt(0)
    v_mfma_f32_32x32x16_bf16 v[224:239], v[36:39], v[100:103], v[224:239]
    v_add_u32 v196, v164, v11
    ds_read_b128 v[104:107], v196 offset:0
    ds_read_b128 v[108:111], v196 offset:32
    ds_read_b128 v[112:115], v196 offset:64
    ds_read_b128 v[116:119], v196 offset:96
    s_waitcnt lgkmcnt(3)
    v_mfma_f32_32x32x16_bf16 v[224:239], v[24:27], v[104:107], v[224:239]
    s_waitcnt lgkmcnt(2)
    v_mfma_f32_32x32x16_bf16 v[224:239], v[28:31], v[108:111], v[224:239]
    s_waitcnt lgkmcnt(1)
    v_mfma_f32_32x32x16_bf16 v[224:239], v[32:35], v[112:115], v[224:239]
    s_waitcnt lgkmcnt(0)
    v_mfma_f32_32x32x16_bf16 v[224:239], v[36:39], v[116:119], v[224:239]
    v_add_u32 v196, v165, v11
    ds_read_b128 v[120:123], v196 offset:0
    ds_read_b128 v[124:127], v196 offset:32
    ds_read_b128 v[128:131], v196 offset:64
    ds_read_b128 v[132:135], v196 offset:96
    s_waitcnt lgkmcnt(3)
    v_mfma_f32_32x32x16_bf16 v[224:239], v[24:27], v[120:123], v[224:239]
    s_waitcnt lgkmcnt(2)
    v_mfma_f32_32x32x16_bf16 v[224:239], v[28:31], v[124:127], v[224:239]
    s_waitcnt lgkmcnt(1)
    v_mfma_f32_32x32x16_bf16 v[224:239], v[32:35], v[128:131], v[224:239]
    s_waitcnt lgkmcnt(0)
    v_mfma_f32_32x32x16_bf16 v[224:239], v[36:39], v[132:135], v[224:239]
    v_add_u32 v196, v166, v11
    ds_read_b128 v[88:91], v196 offset:0
    ds_read_b128 v[92:95], v196 offset:32
    ds_read_b128 v[96:99], v196 offset:64
    ds_read_b128 v[100:103], v196 offset:96
    s_waitcnt lgkmcnt(3)
    v_mfma_f32_32x32x16_bf16 v[224:239], v[24:27], v[88:91], v[224:239]
    s_waitcnt lgkmcnt(2)
    v_mfma_f32_32x32x16_bf16 v[224:239], v[28:31], v[92:95], v[224:239]
    s_waitcnt lgkmcnt(1)
    v_mfma_f32_32x32x16_bf16 v[224:239], v[32:35], v[96:99], v[224:239]
    s_waitcnt lgkmcnt(0)
    v_mfma_f32_32x32x16_bf16 v[224:239], v[36:39], v[100:103], v[224:239]
    v_add_u32 v196, v167, v11
    ds_read_b128 v[104:107], v196 offset:0
    ds_read_b128 v[108:111], v196 offset:32
    ds_read_b128 v[112:115], v196 offset:64
    ds_read_b128 v[116:119], v196 offset:96
    s_waitcnt lgkmcnt(3)
    v_mfma_f32_32x32x16_bf16 v[224:239], v[24:27], v[104:107], v[224:239]
    s_waitcnt lgkmcnt(2)
    v_mfma_f32_32x32x16_bf16 v[224:239], v[28:31], v[108:111], v[224:239]
    s_waitcnt lgkmcnt(1)
    v_mfma_f32_32x32x16_bf16 v[224:239], v[32:35], v[112:115], v[224:239]
    s_waitcnt lgkmcnt(0)
    v_mfma_f32_32x32x16_bf16 v[224:239], v[36:39], v[116:119], v[224:239]
    s_nop 7
L2_mp_done:
    s_waitcnt lgkmcnt(0)
    s_barrier
    s_cmp_lt_u32 s30, 256
    s_cbranch_scc1 L2_nextround
    s_mov_b32 s56, 0xbf317218
    s_mov_b32 s57, 0xbf317218
    v_exp_f32 v56, v224
    v_exp_f32 v57, v225
    v_exp_f32 v58, v226
    v_exp_f32 v59, v227
    v_exp_f32 v60, v228
    v_exp_f32 v61, v229
    v_exp_f32 v62, v230
    v_exp_f32 v63, v231
    v_exp_f32 v64, v232
    v_exp_f32 v65, v233
    v_exp_f32 v66, v234
    v_exp_f32 v67, v235
    v_exp_f32 v68, v236
    v_exp_f32 v69, v237
    v_exp_f32 v70, v238
    v_exp_f32 v71, v239
    v_pk_mul_f32 v[224:225], v[224:225], s[56:57]
    v_pk_mul_f32 v[226:227], v[226:227], s[56:57]
    v_pk_mul_f32 v[228:229], v[228:229], s[56:57]
    v_pk_mul_f32 v[230:231], v[230:231], s[56:57]
    v_pk_mul_f32 v[232:233], v[232:233], s[56:57]
    v_pk_mul_f32 v[234:235], v[234:235], s[56:57]
    v_pk_mul_f32 v[236:237], v[236:237], s[56:57]
    v_pk_mul_f32 v[238:239], v[238:239], s[56:57]
    v_pk_add_f32 v[56:57], v[56:57], 1.0 op_sel_hi:[1,0]
    v_pk_add_f32 v[58:59], v[58:59], 1.0 op_sel_hi:[1,0]
    v_pk_add_f32 v[60:61], v[60:61], 1.0 op_sel_hi:[1,0]
    v_pk_add_f32 v[62:63], v[62:63], 1.0 op_sel_hi:[1,0]
    v_pk_add_f32 v[64:65], v[64:65], 1.0 op_sel_hi:[1,0]
    v_pk_add_f32 v[66:67], v[66:67], 1.0 op_sel_hi:[1,0]
    v_pk_add_f32 v[68:69], v[68:69], 1.0 op_sel_hi:[1,0]
    v_pk_add_f32 v[70:71], v[70:71], 1.0 op_sel_hi:[1,0]
    v_cmpx_gt_u32 vcc, s97, v9
    v_rcp_f32 v56, v56
    v_rcp_f32 v57, v57
    v_rcp_f32 v58, v58
    v_rcp_f32 v59, v59
    s_nop 0
    v_pk_fma_f32 v[144:145], v[56:57], v[224:225], v[144:145]
    v_pk_fma_f32 v[146:147], v[58:59], v[226:227], v[146:147]
    v_cvt_pk_bf16_f32 v184, v144, v145
    v_cvt_pk_bf16_f32 v185, v146, v147
    buffer_store_dwordx2 v[184:185], v13, s[24:27], s95 offen offset:0
    v_rcp_f32 v60, v60
    v_rcp_f32 v61, v61
    v_rcp_f32 v62, v62
    v_rcp_f32 v63, v63
    s_nop 0
    v_pk_fma_f32 v[148:149], v[60:61], v[228:229], v[148:149]
    v_pk_fma_f32 v[150:151], v[62:63], v[230:231], v[150:151]
    v_cvt_pk_bf16_f32 v186, v148, v149
    v_cvt_pk_bf16_f32 v187, v150, v151
    buffer_store_dwordx2 v[186:187], v13, s[24:27], s95 offen offset:16
    v_rcp_f32 v64, v64
    v_rcp_f32 v65, v65
    v_rcp_f32 v66, v66
    v_rcp_f32 v67, v67
    s_nop 0
    v_pk_fma_f32 v[152:153], v[64:65], v[232:233], v[152:153]
    v_pk_fma_f32 v[154:155], v[66:67], v[234:235], v[154:155]
    v_cvt_pk_bf16_f32 v188, v152, v153
    v_cvt_pk_bf16_f32 v189, v154, v155
    buffer_store_dwordx2 v[188:189], v13, s[24:27], s95 offen offset:32
    v_rcp_f32 v68, v68
    v_rcp_f32 v69, v69
    v_rcp_f32 v70, v70
    v_rcp_f32 v71, v71
    s_nop 0
    v_pk_fma_f32 v[156:157], v[68:69], v[236:237], v[156:157]
    v_pk_fma_f32 v[158:159], v[70:71], v[238:239], v[158:159]
    v_cvt_pk_bf16_f32 v190, v156, v157
    v_cvt_pk_bf16_f32 v191, v158, v159
    buffer_store_dwordx2 v[190:191], v13, s[24:27], s95 offen offset:48
    s_endpgm
L2_epi_pos:
    ds_read_b128 v[160:163], v13 offset:1792
    ds_read_b128 v[164:167], v13 offset:1808
    ds_read_b32 v7, v11 offset:640
    v_mul_f32 v168, v57, v214
    v_mul_f32 v169, v58, v214
    v_mul_f32 v170, v59, v214
    v_mul_f32 v171, v61, v214
    v_mul_f32 v172, v62, v214
    v_mul_f32 v173, v63, v214
    v_mul_f32 v174, v65, v214
    v_mul_f32 v175, v66, v214
    v_mul_f32 v176, v67, v214
    v_mul_f32 v177, v69, v214
    v_mul_f32 v178, v70, v214
    v_mul_f32 v179, v71, v214
    v_fmac_f32 v168, v73, v215
    v_fmac_f32 v169, v74, v215
    v_fmac_f32 v170, v75, v215
    v_fmac_f32 v171, v77, v215
    v_fmac_f32 v172, v78, v215
    v_fmac_f32 v173, v79, v215
    v_fmac_f32 v174, v81, v215
    v_fmac_f32 v175, v82, v215
    v_fmac_f32 v176, v83, v215
    v_fmac_f32 v177, v85, v215
    v_fmac_f32 v178, v86, v215
    v_fmac_f32 v179, v87, v215
    v_permlane16_swap_b32 v168, v169
    v_permlane16_swap_b32 v170, v171
    v_permlane16_swap_b32 v172, v173
    v_permlane16_swap_b32 v174, v175
    v_permlane16_swap_b32 v176, v177
    v_permlane16_swap_b32 v178, v179
    v_add_f32 v168, v168, v169
    v_add_f32 v170, v170, v171
    v_add_f32 v172, v172, v173
    v_add_f32 v174, v174, v175
    v_add_f32 v176, v176, v177
    v_add_f32 v178, v178, v179
    ds_write_b32 v219, v168 offset:1152
    ds_write_b32 v219, v170 offset:1408
    ds_write_b32 v219, v172 offset:1664
    ds_write_b32 v219, v174 offset:1920
    ds_write_b32 v219, v176 offset:2176
    ds_write_b32 v219, v178 offset:2432
    s_waitcnt lgkmcnt(0)
    s_barrier
    s_cmp_ge_u32 s29, 6
    s_cbranch_scc1 L2_pos_end
    v_cmp_ne_u32 vcc, s60, v160
    v_add_u32 v160, v160, v10
    s_cbranch_vccz L2_pp0
    ds_read_b128 v[88:91], v160 offset:1152
    ds_read_b128 v[92:95], v160 offset:1168
    ds_read_b128 v[96:99], v160 offset:1184
    ds_read_b128 v[100:103], v160 offset:1200
    s_waitcnt lgkmcnt(0)
    v_pk_add_f32 v[88:89], v[88:89], v[96:97]
    v_pk_add_f32 v[90:91], v[90:91], v[98:99]
    v_pk_add_f32 v[92:93], v[92:93], v[100:101]
    v_pk_add_f32 v[94:95], v[94:95], v[102:103]
    v_pk_add_f32 v[88:89], v[88:89], v[92:93]
    v_pk_add_f32 v[90:91], v[90:91], v[94:95]
    v_pk_add_f32 v[88:89], v[88:89], v[90:91]
    v_add_f32 v244, v244, v88
    v_add_f32 v244, v244, v89
L2_pp0:
    v_cmp_ne_u32 vcc, s60, v161
    v_add_u32 v161, v161, v10
    s_cbranch_vccz L2_pp1
    ds_read_b128 v[88:91], v161 offset:1152
    ds_read_b128 v[92:95], v161 offset:1168
    ds_read_b128 v[96:99], v161 offset:1184
    ds_read_b128 v[100:103], v161 offset:1200
    s_waitcnt lgkmcnt(0)
    v_pk_add_f32 v[88:89], v[88:89], v[96:97]
    v_pk_add_f32 v[90:91], v[90:91], v[98:99]
    v_pk_add_f32 v[92:93], v[92:93], v[100:101]
    v_pk_add_f32 v[94:95], v[94:95], v[102:103]
    v_pk_add_f32 v[88:89], v[88:89], v[92:93]
    v_pk_add_f32 v[90:91], v[90:91], v[94:95]
    v_pk_add_f32 v[88:89], v[88:89], v[90:91]
    v_add_f32 v244, v244, v88
    v_add_f32 v244, v244, v89
L2_pp1:
    v_cmp_ne_u32 vcc, s60, v162
    v_add_u32 v162, v162, v10
    s_cbranch_vccz L2_pp2
    ds_read_b128 v[88:91], v162 offset:1152
    ds_read_b128 v[92:95], v162 offset:1168
    ds_read_b128 v[96:99], v162 offset:1184
    ds_read_b128 v[100:103], v162 offset:1200
    s_waitcnt lgkmcnt(0)
    v_pk_add_f32 v[88:89], v[88:89], v[96:97]
    v_pk_add_f32 v[90:91], v[90:91], v[98:99]
    v_pk_add_f32 v[92:93], v[92:93], v[100:101]
    v_pk_add_f32 v[94:95], v[94:95], v[102:103]
    v_pk_add_f32 v[88:89], v[88:89], v[92:93]
    v_pk_add_f32 v[90:91], v[90:91], v[94:95]
    v_pk_add_f32 v[88:89], v[88:89], v[90:91]
    v_add_f32 v244, v244, v88
    v_add_f32 v244, v244, v89
L2_pp2:
    v_cmp_ne_u32 vcc, s60, v163
    v_add_u32 v163, v163, v10
    s_cbranch_vccz L2_pp3
    ds_read_b128 v[88:91], v163 offset:1152
    ds_read_b128 v[92:95], v163 offset:1168
    ds_read_b128 v[96:99], v163 offset:1184
    ds_read_b128 v[100:103], v163 offset:1200
    s_waitcnt lgkmcnt(0)
    v_pk_add_f32 v[88:89], v[88:89], v[96:97]
    v_pk_add_f32 v[90:91], v[90:91], v[98:99]
    v_pk_add_f32 v[92:93], v[92:93], v[100:101]
    v_pk_add_f32 v[94:95], v[94:95], v[102:103]
    v_pk_add_f32 v[88:89], v[88:89], v[92:93]
    v_pk_add_f32 v[90:91], v[90:91], v[94:95]
    v_pk_add_f32 v[88:89], v[88:89], v[90:91]
    v_add_f32 v244, v244, v88
    v_add_f32 v244, v244, v89
L2_pp3:
    v_cmp_ne_u32 vcc, s60, v164
    v_add_u32 v164, v164, v10
    s_cbranch_vccz L2_pp4
    ds_read_b128 v[88:91], v164 offset:1152
    ds_read_b128 v[92:95], v164 offset:1168
    ds_read_b128 v[96:99], v164 offset:1184
    ds_read_b128 v[100:103], v164 offset:1200
    s_waitcnt lgkmcnt(0)
    v_pk_add_f32 v[88:89], v[88:89], v[96:97]
    v_pk_add_f32 v[90:91], v[90:91], v[98:99]
    v_pk_add_f32 v[92:93], v[92:93], v[100:101]
    v_pk_add_f32 v[94:95], v[94:95], v[102:103]
    v_pk_add_f32 v[88:89], v[88:89], v[92:93]
    v_pk_add_f32 v[90:91], v[90:91], v[94:95]
    v_pk_add_f32 v[88:89], v[88:89], v[90:91]
    v_add_f32 v244, v244, v88
    v_add_f32 v244, v244, v89
L2_pp4:
    v_cmp_ne_u32 vcc, s60, v165
    v_add_u32 v165, v165, v10
    s_cbranch_vccz L2_pp5
    ds_read_b128 v[88:91], v165 offset:1152
    ds_read_b128 v[92:95], v165 offset:1168
    ds_read_b128 v[96:99], v165 offset:1184
    ds_read_b128 v[100:103], v165 offset:1200
    s_waitcnt lgkmcnt(0)
    v_pk_add_f32 v[88:89], v[88:89], v[96:97]
    v_pk_add_f32 v[90:91], v[90:91], v[98:99]
    v_pk_add_f32 v[92:93], v[92:93], v[100:101]
    v_pk_add_f32 v[94:95], v[94:95], v[102:103]
    v_pk_add_f32 v[88:89], v[88:89], v[92:93]
    v_pk_add_f32 v[90:91], v[90:91], v[94:95]
    v_pk_add_f32 v[88:89], v[88:89], v[90:91]
    v_add_f32 v244, v244, v88
    v_add_f32 v244, v244, v89
L2_pp5:
    v_cmp_ne_u32 vcc, s60, v166
    v_add_u32 v166, v166, v10
    s_cbranch_vccz L2_pp6
    ds_read_b128 v[88:91], v166 offset:1152
    ds_read_b128 v[92:95], v166 offset:1168
    ds_read_b128 v[96:99], v166 offset:1184
    ds_read_b128 v[100:103], v166 offset:1200
    s_waitcnt lgkmcnt(0)
    v_pk_add_f32 v[88:89], v[88:89], v[96:97]
    v_pk_add_f32 v[90:91], v[90:91], v[98:99]
    v_pk_add_f32 v[92:93], v[92:93], v[100:101]
    v_pk_add_f32 v[94:95], v[94:95], v[102:103]
    v_pk_add_f32 v[88:89], v[88:89], v[92:93]
    v_pk_add_f32 v[90:91], v[90:91], v[94:95]
    v_pk_add_f32 v[88:89], v[88:89], v[90:91]
    v_add_f32 v244, v244, v88
    v_add_f32 v244, v244, v89
L2_pp6:
    v_cmp_ne_u32 vcc, s60, v167
    v_add_u32 v167, v167, v10
    s_cbranch_vccz L2_pp7
    ds_read_b128 v[88:91], v167 offset:1152
    ds_read_b128 v[92:95], v167 offset:1168
    ds_read_b128 v[96:99], v167 offset:1184
    ds_read_b128 v[100:103], v167 offset:1200
    s_waitcnt lgkmcnt(0)
    v_pk_add_f32 v[88:89], v[88:89], v[96:97]
    v_pk_add_f32 v[90:91], v[90:91], v[98:99]
    v_pk_add_f32 v[92:93], v[92:93], v[100:101]
    v_pk_add_f32 v[94:95], v[94:95], v[102:103]
    v_pk_add_f32 v[88:89], v[88:89], v[92:93]
    v_pk_add_f32 v[90:91], v[90:91], v[94:95]
    v_pk_add_f32 v[88:89], v[88:89], v[90:91]
    v_add_f32 v244, v244, v88
    v_add_f32 v244, v244, v89
L2_pp7:
    s_cmp_lt_u32 s30, 256
    s_cbranch_scc1 L2_nextround
    v_fmac_f32 v7, 0xbf317218, v244
    v_lshlrev_b32 v12, 1, v14
    v_cvt_pk_bf16_f32 v7, v7, v7
    s_mul_i32 s55, s97, 3
    v_cmpx_gt_u32 vcc, s55, v14
    buffer_store_short v7, v12, s[24:27], s95 offen
    s_endpgm
L2_pos_end:
    s_cmp_ge_u32 s30, 256
    s_cbranch_scc1 L_done
L2_nextround:
    s_waitcnt vmcnt(0) lgkmcnt(0)
    s_barrier
    s_add_u32 m0, s84, 102400
    s_nop 0
    buffer_load_dwordx4 v3, s[8:11], s84 offen offset:0 lds
    buffer_load_dwordx4 v3, s[8:11], s84 offen offset:1024 lds
    s_add_u32 m0, s84, 102400
    s_nop 0
    buffer_load_dwordx4 v3, s[8:11], s84 offen offset:2048 lds
    buffer_load_dwordx4 v3, s[8:11], s84 offen offset:3072 lds
    s_add_u32 m0, s85, 102400
    s_nop 0
    buffer_load_dwordx4 v3, s[8:11], s85 offen offset:0 lds
    buffer_load_dwordx4 v3, s[8:11], s85 offen offset:1024 lds
    s_add_u32 m0, s85, 102400
    s_nop 0
    buffer_load_dwordx4 v3, s[8:11], s85 offen offset:2048 lds
    buffer_load_dwordx4 v3, s[8:11], s85 offen offset:3072 lds
    s_branch L2_round
L_done:
    s_endpgm
.section .rodata,"a"
.p2align 6
.amdhsa_kernel standalone__cheap_equivariant_egnn__graph_kernel
  .amdhsa_next_free_vgpr 250
  .amdhsa_next_free_sgpr 98
  .amdhsa_accum_offset 252
  .amdhsa_group_segment_fixed_size 0
  .amdhsa_kernarg_size 88
  .amdhsa_user_sgpr_count 2
  .amdhsa_user_sgpr_kernarg_segment_ptr 1
  .amdhsa_system_sgpr_workgroup_id_x 1
.end_amdhsa_kernel
```
